```python
import torch

def _softmax(x, axis=-1):
    return torch.softmax(x, dim=axis)
def _gelu(x):
    return torch.nn.functional.gelu(x, approximate="tanh")
def _silu(x):
    return torch.nn.functional.silu(x)
def _sigmoid(x):
    return torch.sigmoid(x)
def _layernorm(x, axis=-1, eps=1e-5):
    m = x.mean(dim=axis, keepdim=True)
    v = x.var(dim=axis, keepdim=True, unbiased=False)
    return (x - m) / torch.sqrt(v + eps)
def _scatter_add(tgt, idx, src, axis=0):
    return tgt.clone().index_add_(axis, idx, src)
def _segment_sum(src, seg, n):
    out = torch.zeros((n,) + src.shape[1:], dtype=src.dtype)
    return out.index_add_(0, seg, src)
def _pad(x, pw):
    flat = tuple(v for pair in reversed(pw) for v in pair)
    return torch.nn.functional.pad(x, flat)

kernel_name = 'standalone__cheap_equivariant_egnn__graph'

def setup_inputs():

    _w = (lambda a: (lambda t: t.to(torch.bfloat16) if t.is_floating_point() else t)(torch.as_tensor(a)))
    N, deg, D, De = 10000, 16, 128, max(16, 1)
    E = N * deg
    return {
        "h": _w((lambda *s: torch.randn(*s, dtype=torch.bfloat16) * 0.2)(N, D)),
        "pos": _w((lambda *s: torch.randn(*s, dtype=torch.bfloat16) * 0.8)(N, 3)),
        "e_attr": _w((lambda *s: torch.randn(*s, dtype=torch.bfloat16) * 0.8)(E, De)),
        "src": _w((lambda lo, hi, *s: torch.randint(lo, hi, s))(0, N, E).to(torch.int64)),
        "dst": _w((lambda lo, hi, *s: torch.randint(lo, hi, s))(0, N, E).to(torch.int64)),
        "w_e": _w(0.1 * (lambda *s: torch.randn(*s, dtype=torch.bfloat16) * 0.8)(2 * D + 1 + De, D)),
        "w_x": _w(0.1 * (lambda *s: torch.randn(*s, dtype=torch.bfloat16) * 0.2)(D, 1)),
        "w_h": _w(0.1 * (lambda *s: torch.randn(*s, dtype=torch.bfloat16) * 0.2)(2 * D, D)),
    }

def reference(h, pos, e_attr, src, dst, w_e, w_x, w_h):
    N, D = h.shape[0], h.shape[1]
    diff = pos[dst] - pos[src]
    dist2 = torch.sum(diff * diff, axis=-1, keepdims=True)
    e_in = torch.concatenate([h[dst], h[src], dist2, e_attr], axis=-1)
    m_ij = _silu(e_in @ w_e)
    coord_scale = m_ij @ w_x
    pos_new = pos + _segment_sum(diff * coord_scale, dst, N)
    m_i = _segment_sum(m_ij, dst, N)
    h_new = h + _silu(torch.concatenate([h, m_i], axis=-1) @ w_h)
    return h_new, pos_new
```

```asm
; @launch kernel=k1_kernel grid=(264,1,1) block=(512,1,1) lds=50176
; @launch kernel=k2_kernel grid=(250,1,1) block=(512,1,1) lds=163840
.amdgcn_target "amdgcn-amd-amdhsa--gfx950"
.text

.globl k1_kernel
.p2align 8
.type k1_kernel,@function
k1_kernel:
    s_cmp_ge_u32 s2, 157
    s_cbranch_scc1 K1_notgemm
    s_load_dwordx2 s[4:5], s[0:1], 40
    s_load_dwordx2 s[8:9], s[0:1], 0
    s_load_dwordx2 s[16:17], s[0:1], 80
    v_and_b32 v1, 63, v0
    v_lshrrev_b32 v2, 6, v0
    s_lshl_b32 s20, s2, 6
    v_readfirstlane_b32 s21, v2
    s_mov_b32 s6, 69888
    s_mov_b32 s7, 0x00020000
    v_lshrrev_b32 v4, 4, v1
    v_and_b32 v3, 15, v1
    v_lshlrev_b32 v5, 2, v4
    v_xor_b32 v3, v3, v5
    v_lshlrev_b32 v3, 4, v3
    v_lshl_add_u32 v3, v4, 8, v3
    v_and_b32 v5, 15, v1
    v_xor_b32 v5, v5, v4
    v_lshlrev_b32 v7, 4, v5
    s_mov_b32 s10, 10000
    s_mov_b32 s11, 0x00020000
    s_lshl_b32 s22, s21, 12
    s_add_u32 s23, s22, 32768
    s_lshl_b32 s24, s21, 3
    s_add_u32 s24, s24, s20
    v_add_u32 v6, s24, v4
    v_add_u32 v8, 4, v6
    v_mov_b32 v9, v7
    s_mul_i32 s25, s21, 2176
    s_add_u32 s25, s25, 32768
    s_waitcnt lgkmcnt(0)
    s_or_b32 s9, s9, 0x1000000
    s_add_u32 m0, s25, 0
    s_nop 0
    buffer_load_dwordx4 v[6:7], s[8:11], 0 idxen offen lds
    s_add_u32 m0, s25, 1088
    s_nop 0
    buffer_load_dwordx4 v[8:9], s[8:11], 0 idxen offen lds
    s_add_u32 m0, s22, 0
    s_add_u32 s26, s23, 0
    buffer_load_dwordx4 v3, s[4:7], s26 offen lds
    s_add_u32 m0, s22, 1024
    s_add_u32 s26, s23, 1024
    buffer_load_dwordx4 v3, s[4:7], s26 offen lds
    s_add_u32 m0, s22, 2048
    s_add_u32 s26, s23, 2048
    buffer_load_dwordx4 v3, s[4:7], s26 offen lds
    s_add_u32 m0, s22, 3072
    s_add_u32 s26, s23, 3072
    buffer_load_dwordx4 v3, s[4:7], s26 offen lds
    s_lshr_b32 s26, s21, 2
    s_and_b32 s27, s21, 3
    v_lshrrev_b32 v14, 5, v1
    v_lshlrev_b32 v14, 3, v14
    v_bfe_u32 v15, v1, 2, 2
    v_add_u32 v14, v14, v15
    v_lshlrev_b32 v14, 8, v14
    v_bfe_u32 v15, v1, 4, 1
    v_lshl_add_u32 v14, v15, 5, v14
    v_and_b32 v15, 3, v1
    v_lshl_add_u32 v14, v15, 3, v14
    v_bfe_u32 v15, v1, 2, 2
    v_xor_b32 v15, s27, v15
    v_lshl_add_u32 v14, v15, 6, v14
    v_and_b32 v15, 31, v1
    v_lshrrev_b32 v16, 2, v15
    s_lshl_b32 s28, s26, 3
    v_add_u32 v16, s28, v16
    v_mul_u32_u24 v16, 1088, v16
    v_and_b32 v17, 3, v15
    v_lshl_add_u32 v16, v17, 8, v16
    v_add_u32 v16, 32768, v16
    v_lshrrev_b32 v18, 5, v1
    v_xor_b32 v18, v18, v17
    v_lshl_add_u32 v19, v18, 4, v16
    v_xor_b32 v18, 2, v18
    v_lshl_add_u32 v16, v18, 4, v16
    s_lshl_b32 s28, s26, 5
    s_add_u32 s28, s28, s20
    v_add_u32 v18, s28, v15
    v_lshlrev_b32 v18, 8, v18
    v_lshrrev_b32 v17, 5, v1
    v_lshl_add_u32 v18, v17, 4, v18
    s_lshl_b32 s28, s27, 6
    v_add_u32 v18, s28, v18
    s_add_u32 s16, s16, 3276800
    s_addc_u32 s17, s17, 0
    s_mov_b32 s18, 2560000
    s_mov_b32 s19, 0x00020000
    s_mov_b32 s28, 0xbfb8aa3b
    s_waitcnt vmcnt(0)
    s_barrier
    ds_read_b64_tr_b16 v[20:21], v14 offset:0
    ds_read_b64_tr_b16 v[22:23], v14 offset:1024
    ds_read_b64_tr_b16 v[24:25], v14 offset:4096
    ds_read_b64_tr_b16 v[26:27], v14 offset:5120
    ds_read_b64_tr_b16 v[28:29], v14 offset:8192
    ds_read_b64_tr_b16 v[30:31], v14 offset:9216
    ds_read_b64_tr_b16 v[32:33], v14 offset:12288
    ds_read_b64_tr_b16 v[34:35], v14 offset:13312
    ds_read_b128 v[52:55], v19 offset:0
    ds_read_b128 v[56:59], v16 offset:0
    ds_read_b128 v[60:63], v19 offset:64
    ds_read_b128 v[64:67], v16 offset:64
    s_waitcnt lgkmcnt(4)
    ds_read_b64_tr_b16 v[36:37], v14 offset:16384
    ds_read_b64_tr_b16 v[38:39], v14 offset:17408
    ds_read_b64_tr_b16 v[40:41], v14 offset:20480
    ds_read_b64_tr_b16 v[42:43], v14 offset:21504
    ds_read_b64_tr_b16 v[44:45], v14 offset:24576
    ds_read_b64_tr_b16 v[46:47], v14 offset:25600
    ds_read_b64_tr_b16 v[48:49], v14 offset:28672
    ds_read_b64_tr_b16 v[50:51], v14 offset:29696
    s_waitcnt lgkmcnt(8)
    ds_read_b128 v[68:71], v19 offset:128
    ds_read_b128 v[72:75], v16 offset:128
    ds_read_b128 v[76:79], v19 offset:192
    ds_read_b128 v[80:83], v16 offset:192
    v_mfma_f32_32x32x16_bf16 v[84:99], v[20:23], v[52:55], 0
    v_mfma_f32_32x32x16_bf16 v[84:99], v[24:27], v[56:59], v[84:99]
    v_mfma_f32_32x32x16_bf16 v[84:99], v[28:31], v[60:63], v[84:99]
    v_mfma_f32_32x32x16_bf16 v[84:99], v[32:35], v[64:67], v[84:99]
    s_waitcnt lgkmcnt(0)
    v_mfma_f32_32x32x16_bf16 v[84:99], v[36:39], v[68:71], v[84:99]
    v_mfma_f32_32x32x16_bf16 v[84:99], v[40:43], v[72:75], v[84:99]
    v_mfma_f32_32x32x16_bf16 v[84:99], v[44:47], v[76:79], v[84:99]
    v_mfma_f32_32x32x16_bf16 v[84:99], v[48:51], v[80:83], v[84:99]
    s_nop 7
    s_nop 3
    v_mul_f32 v84, s28, v84
    v_mul_f32 v85, s28, v85
    v_mul_f32 v86, s28, v86
    v_mul_f32 v87, s28, v87
    v_mul_f32 v88, s28, v88
    v_mul_f32 v89, s28, v89
    v_mul_f32 v90, s28, v90
    v_mul_f32 v91, s28, v91
    v_mul_f32 v92, s28, v92
    v_mul_f32 v93, s28, v93
    v_mul_f32 v94, s28, v94
    v_mul_f32 v95, s28, v95
    v_mul_f32 v96, s28, v96
    v_mul_f32 v97, s28, v97
    v_mul_f32 v98, s28, v98
    v_mul_f32 v99, s28, v99
    v_cvt_pk_bf16_f32 v20, v84, v85
    v_cvt_pk_bf16_f32 v21, v86, v87
    v_cvt_pk_bf16_f32 v22, v88, v89
    v_cvt_pk_bf16_f32 v23, v90, v91
    v_cvt_pk_bf16_f32 v24, v92, v93
    v_cvt_pk_bf16_f32 v25, v94, v95
    v_cvt_pk_bf16_f32 v26, v96, v97
    v_cvt_pk_bf16_f32 v27, v98, v99
    s_nop 1
    v_permlane32_swap_b32 v20, v22
    v_permlane32_swap_b32 v21, v23
    v_permlane32_swap_b32 v24, v26
    v_permlane32_swap_b32 v25, v27
    s_nop 1
    buffer_store_dwordx4 v[20:23], v18, s[16:19], 0 offen nt
    buffer_store_dwordx4 v[24:27], v18, s[16:19], 0 offen offset:32 nt
    s_endpgm
K1_notgemm:
    s_cmp_ge_u32 s2, 264
    s_cbranch_scc1 K1_done
    s_cmp_lt_u32 s2, 160
    s_cbranch_scc1 K1_done
    s_cmp_ge_u32 s2, 256
    s_cbranch_scc1 K1_pref
    s_cmp_ge_u32 s2, 224
    s_cbranch_scc1 K1_prep
    s_load_dwordx4 s[4:7], s[0:1], 24
    s_load_dwordx2 s[8:9], s[0:1], 80
    v_lshlrev_b32 v1, 4, v0
    v_lshlrev_b32 v2, 2, v0
    v_mov_b32 v4, -1
    v_mov_b32 v5, -1
    v_mov_b32 v6, -1
    v_mov_b32 v7, -1
    v_mov_b32 v3, 0
    ds_write_b128 v1, v[4:7] offset:0
    ds_write_b128 v1, v[4:7] offset:8192
    ds_write_b128 v1, v[4:7] offset:16384
    ds_write_b128 v1, v[4:7] offset:24576
    ds_write_b32 v2, v3 offset:32768
    s_sub_u32 s23, s2, 160
    s_mul_i32 s10, s23, 10000
    s_waitcnt lgkmcnt(0)
    s_add_u32 s12, s4, s10
    s_addc_u32 s13, s5, 0
    s_mov_b32 s14, 10000
    s_mov_b32 s15, 0x00020000
    s_add_u32 s16, s6, s10
    s_addc_u32 s17, s7, 0
    s_mov_b32 s18, 10000
    s_mov_b32 s19, 0x00020000
    buffer_load_dword v11, v2, s[16:19], 0 offen
    buffer_load_dword v10, v2, s[12:15], 0 offen
    s_movk_i32 s40, 2048
    buffer_load_dword v13, v2, s[16:19], s40 offen
    buffer_load_dword v12, v2, s[12:15], s40 offen
    s_movk_i32 s41, 4096
    buffer_load_dword v15, v2, s[16:19], s41 offen
    buffer_load_dword v14, v2, s[12:15], s41 offen
    s_movk_i32 s42, 6144
    buffer_load_dword v17, v2, s[16:19], s42 offen
    buffer_load_dword v16, v2, s[12:15], s42 offen
    s_movk_i32 s43, 8192
    buffer_load_dword v19, v2, s[16:19], s43 offen
    buffer_load_dword v18, v2, s[12:15], s43 offen
    s_mov_b32 s24, s8
    s_and_b32 s25, s9, 0xffff
    s_mov_b32 s26, 2048000
    s_mov_b32 s27, 0x00020000
    s_lshl_b32 s22, s23, 7
    v_mov_b32 v30, 1
    s_movk_i32 s33, 452
    v_cmp_gt_u32 s[30:31], s33, v0
    s_barrier
    s_waitcnt vmcnt(8)
    v_mul_u32_u24 v32, 52429, v11
    v_lshrrev_b32 v32, 21, v32
    v_lshlrev_b32 v26, 2, v32
    ds_add_rtn_u32 v48, v26, v30 offset:32768
    v_mul_u32_u24 v24, 40, v32
    v_sub_u32 v24, v11, v24
    v_lshl_or_b32 v40, v24, 14, v10
    v_add_u32 v25, 0, v0
    v_lshl_or_b32 v40, v25, 20, v40
    s_waitcnt vmcnt(6)
    v_mul_u32_u24 v33, 52429, v13
    v_lshrrev_b32 v33, 21, v33
    v_lshlrev_b32 v26, 2, v33
    ds_add_rtn_u32 v49, v26, v30 offset:32768
    v_mul_u32_u24 v24, 40, v33
    v_sub_u32 v24, v13, v24
    v_lshl_or_b32 v41, v24, 14, v12
    v_add_u32 v25, 512, v0
    v_lshl_or_b32 v41, v25, 20, v41
    s_waitcnt vmcnt(4)
    v_mul_u32_u24 v34, 52429, v15
    v_lshrrev_b32 v34, 21, v34
    v_lshlrev_b32 v26, 2, v34
    ds_add_rtn_u32 v50, v26, v30 offset:32768
    v_mul_u32_u24 v24, 40, v34
    v_sub_u32 v24, v15, v24
    v_lshl_or_b32 v42, v24, 14, v14
    v_add_u32 v25, 1024, v0
    v_lshl_or_b32 v42, v25, 20, v42
    s_waitcnt vmcnt(2)
    v_mul_u32_u24 v35, 52429, v17
    v_lshrrev_b32 v35, 21, v35
    v_lshlrev_b32 v26, 2, v35
    ds_add_rtn_u32 v51, v26, v30 offset:32768
    v_mul_u32_u24 v24, 40, v35
    v_sub_u32 v24, v17, v24
    v_lshl_or_b32 v43, v24, 14, v16
    v_add_u32 v25, 1536, v0
    v_lshl_or_b32 v43, v25, 20, v43
    s_waitcnt vmcnt(0)
    v_mul_u32_u24 v36, 52429, v19
    v_lshrrev_b32 v36, 21, v36
    v_lshlrev_b32 v26, 2, v36
    s_mov_b64 exec, s[30:31]
    ds_add_rtn_u32 v52, v26, v30 offset:32768
    v_mul_u32_u24 v24, 40, v36
    v_sub_u32 v24, v19, v24
    v_lshl_or_b32 v44, v24, 14, v18
    v_add_u32 v25, 2048, v0
    v_lshl_or_b32 v44, v25, 20, v44
    s_mov_b64 exec, -1
    s_waitcnt lgkmcnt(0)
    v_cmp_gt_u32 vcc, 32, v48
    v_and_b32 v24, 7, v48
    v_lshlrev_b32 v24, 4, v24
    v_lshl_add_u32 v24, v32, 7, v24
    v_lshrrev_b32 v25, 3, v48
    v_lshl_add_u32 v24, v25, 2, v24
    s_mov_b64 exec, vcc
    ds_write_b32 v24, v40
    s_mov_b64 exec, -1
    v_cmp_gt_u32 vcc, 32, v49
    v_and_b32 v24, 7, v49
    v_lshlrev_b32 v24, 4, v24
    v_lshl_add_u32 v24, v33, 7, v24
    v_lshrrev_b32 v25, 3, v49
    v_lshl_add_u32 v24, v25, 2, v24
    s_mov_b64 exec, vcc
    ds_write_b32 v24, v41
    s_mov_b64 exec, -1
    v_cmp_gt_u32 vcc, 32, v50
    v_and_b32 v24, 7, v50
    v_lshlrev_b32 v24, 4, v24
    v_lshl_add_u32 v24, v34, 7, v24
    v_lshrrev_b32 v25, 3, v50
    v_lshl_add_u32 v24, v25, 2, v24
    s_mov_b64 exec, vcc
    ds_write_b32 v24, v42
    s_mov_b64 exec, -1
    v_cmp_gt_u32 vcc, 32, v51
    v_and_b32 v24, 7, v51
    v_lshlrev_b32 v24, 4, v24
    v_lshl_add_u32 v24, v35, 7, v24
    v_lshrrev_b32 v25, 3, v51
    v_lshl_add_u32 v24, v25, 2, v24
    s_mov_b64 exec, vcc
    ds_write_b32 v24, v43
    s_mov_b64 exec, -1
    v_cmp_gt_u32 vcc, 32, v52
    v_and_b32 v24, 7, v52
    v_lshlrev_b32 v24, 4, v24
    v_lshl_add_u32 v24, v36, 7, v24
    v_lshrrev_b32 v25, 3, v52
    v_lshl_add_u32 v24, v25, 2, v24
    s_and_b64 vcc, vcc, s[30:31]
    s_mov_b64 exec, vcc
    ds_write_b32 v24, v44
    s_mov_b64 exec, -1
    s_waitcnt lgkmcnt(0)
    s_barrier
    ds_read_b128 v[8:11], v1 offset:0
    ds_read_b128 v[12:15], v1 offset:8192
    ds_read_b128 v[16:19], v1 offset:16384
    ds_read_b128 v[20:23], v1 offset:24576
    v_lshrrev_b32 v26, 3, v0
    v_lshlrev_b32 v27, 2, v26
    ds_read_b32 v32, v27 offset:32768
    ds_read_b32 v33, v27 offset:33024
    ds_read_b32 v34, v27 offset:33280
    ds_read_b32 v35, v27 offset:33536
    v_and_b32 v28, 7, v0
    v_lshlrev_b32 v29, 4, v28
    v_lshl_add_u32 v29, v26, 13, v29
    v_mov_b32 v31, -2
    v_cmp_eq_u32 s[30:31], 0, v28
    s_waitcnt lgkmcnt(0)
    v_cmp_lt_u32 vcc, 32, v32
    s_and_b64 vcc, vcc, s[30:31]
    s_nop 0
    v_add_u32 v36, 0, v29
    v_cndmask_b32 v8, v8, v31, vcc
    v_cmp_lt_u32 vcc, 32, v33
    s_and_b64 vcc, vcc, s[30:31]
    s_mov_b32 s34, 524288
    v_add_u32 v37, 524288, v29
    v_cndmask_b32 v12, v12, v31, vcc
    v_cmp_lt_u32 vcc, 32, v34
    s_and_b64 vcc, vcc, s[30:31]
    s_mov_b32 s34, 1048576
    v_add_u32 v38, 1048576, v29
    v_cndmask_b32 v16, v16, v31, vcc
    v_cmp_lt_u32 vcc, 32, v35
    s_and_b64 vcc, vcc, s[30:31]
    s_mov_b32 s34, 1572864
    v_add_u32 v39, 1572864, v29
    v_cndmask_b32 v20, v20, v31, vcc
    buffer_store_dwordx4 v[8:11], v36, s[24:27], s22 offen
    buffer_store_dwordx4 v[12:15], v37, s[24:27], s22 offen
    buffer_store_dwordx4 v[16:19], v38, s[24:27], s22 offen
    buffer_store_dwordx4 v[20:23], v39, s[24:27], s22 offen
    s_endpgm
K1_prep:
    s_load_dwordx2 s[4:5], s[0:1], 40
    s_load_dwordx2 s[6:7], s[0:1], 56
    s_load_dwordx2 s[8:9], s[0:1], 80
    s_sub_u32 s10, s2, 224
    s_lshr_b32 s10, s10, 3
    s_lshl_b32 s10, s10, 9
    s_and_b32 s26, s2, 7
    s_mul_i32 s26, s26, 139264
    s_add_u32 s26, s26, 2097152
    v_lshrrev_b32 v2, 6, v0
    s_nop 0
    v_readfirstlane_b32 s27, v2
    s_lshl_b32 s27, s27, 6
    s_add_u32 s27, s27, s10
    v_and_b32 v2, 63, v0
    s_waitcnt lgkmcnt(0)
    s_mov_b32 s16, s4
    s_and_b32 s17, s5, 0xffff
    s_mov_b32 s18, 69888
    s_mov_b32 s19, 0x00020000
    s_mov_b32 s28, s6
    s_and_b32 s29, s7, 0xffff
    s_mov_b32 s30, 65536
    s_mov_b32 s31, 0x00020000
    s_mov_b32 s20, s8
    s_and_b32 s21, s9, 0xffff
    s_mov_b32 s22, 5836800
    s_mov_b32 s23, 0x00020000
    s_add_u32 s36, s27, 0
    s_cmp_ge_u32 s36, 6400
    s_cbranch_scc1 K1_pr0x
    s_cmp_ge_u32 s36, 2304
    s_cbranch_scc1 K1_pr0h
    s_lshr_b32 s12, s36, 8
    s_lshl_b32 s13, s12, 4
    s_cmp_eq_u32 s12, 8
    s_cselect_b32 s13, 257, s13
    s_cselect_b32 s40, 0xbfb8aa3b, 1.0
    s_cselect_b32 s25, 32768, 0
    s_lshr_b32 s15, s36, 6
    s_and_b32 s15, s15, 3
    s_lshl_b32 s15, s15, 5
    v_lshrrev_b32 v3, 5, v2
    v_lshlrev_b32 v3, 3, v3
    v_add_u32 v3, s13, v3
    v_and_b32 v4, 31, v2
    v_add_u32 v4, s15, v4
    v_lshlrev_b32 v3, 8, v3
    v_lshl_add_u32 v3, v4, 1, v3
    s_add_u32 s44, s25, s26
    buffer_load_ushort v8, v3, s[16:19], 0 offen offset:0
    buffer_load_ushort v9, v3, s[16:19], 0 offen offset:256
    buffer_load_ushort v10, v3, s[16:19], 0 offen offset:512
    buffer_load_ushort v11, v3, s[16:19], 0 offen offset:768
    buffer_load_ushort v12, v3, s[16:19], 0 offen offset:1024
    buffer_load_ushort v13, v3, s[16:19], 0 offen offset:1280
    buffer_load_ushort v14, v3, s[16:19], 0 offen offset:1536
    buffer_load_ushort v15, v3, s[16:19], 0 offen offset:1792
    s_branch K1_pr0d
K1_pr0h:
    s_sub_u32 s12, s36, 2304
    s_lshr_b32 s13, s12, 6
    s_and_b32 s13, s13, 7
    s_lshl_b32 s13, s13, 5
    s_lshr_b32 s15, s12, 9
    s_lshl_b32 s15, s15, 4
    s_mov_b32 s40, 1.0
    v_lshrrev_b32 v3, 4, v2
    v_lshlrev_b32 v3, 3, v3
    v_add_u32 v3, s13, v3
    v_and_b32 v4, 15, v2
    v_add_u32 v4, s15, v4
    v_lshlrev_b32 v3, 8, v3
    v_lshl_add_u32 v3, v4, 1, v3
    s_add_u32 s44, s26, 32768
    buffer_load_ushort v8, v3, s[28:31], 0 offen offset:0
    buffer_load_ushort v9, v3, s[28:31], 0 offen offset:256
    buffer_load_ushort v10, v3, s[28:31], 0 offen offset:512
    buffer_load_ushort v11, v3, s[28:31], 0 offen offset:768
    buffer_load_ushort v12, v3, s[28:31], 0 offen offset:1024
    buffer_load_ushort v13, v3, s[28:31], 0 offen offset:1280
    buffer_load_ushort v14, v3, s[28:31], 0 offen offset:1536
    buffer_load_ushort v15, v3, s[28:31], 0 offen offset:1792
    s_branch K1_pr0d
K1_pr0x:
    s_mov_b32 s44, 0x7fffff00
    s_mov_b32 s40, 1.0
K1_pr0d:
    s_add_u32 s37, s27, 2048
    s_cmp_ge_u32 s37, 6400
    s_cbranch_scc1 K1_pr1x
    s_cmp_ge_u32 s37, 2304
    s_cbranch_scc1 K1_pr1h
    s_lshr_b32 s12, s37, 8
    s_lshl_b32 s13, s12, 4
    s_cmp_eq_u32 s12, 8
    s_cselect_b32 s13, 257, s13
    s_cselect_b32 s41, 0xbfb8aa3b, 1.0
    s_cselect_b32 s25, 32768, 0
    s_lshr_b32 s15, s37, 6
    s_and_b32 s15, s15, 3
    s_lshl_b32 s15, s15, 5
    v_lshrrev_b32 v3, 5, v2
    v_lshlrev_b32 v3, 3, v3
    v_add_u32 v3, s13, v3
    v_and_b32 v4, 31, v2
    v_add_u32 v4, s15, v4
    v_lshlrev_b32 v3, 8, v3
    v_lshl_add_u32 v3, v4, 1, v3
    s_add_u32 s45, s25, s26
    buffer_load_ushort v16, v3, s[16:19], 0 offen offset:0
    buffer_load_ushort v17, v3, s[16:19], 0 offen offset:256
    buffer_load_ushort v18, v3, s[16:19], 0 offen offset:512
    buffer_load_ushort v19, v3, s[16:19], 0 offen offset:768
    buffer_load_ushort v20, v3, s[16:19], 0 offen offset:1024
    buffer_load_ushort v21, v3, s[16:19], 0 offen offset:1280
    buffer_load_ushort v22, v3, s[16:19], 0 offen offset:1536
    buffer_load_ushort v23, v3, s[16:19], 0 offen offset:1792
    s_branch K1_pr1d
K1_pr1h:
    s_sub_u32 s12, s37, 2304
    s_lshr_b32 s13, s12, 6
    s_and_b32 s13, s13, 7
    s_lshl_b32 s13, s13, 5
    s_lshr_b32 s15, s12, 9
    s_lshl_b32 s15, s15, 4
    s_mov_b32 s41, 1.0
    v_lshrrev_b32 v3, 4, v2
    v_lshlrev_b32 v3, 3, v3
    v_add_u32 v3, s13, v3
    v_and_b32 v4, 15, v2
    v_add_u32 v4, s15, v4
    v_lshlrev_b32 v3, 8, v3
    v_lshl_add_u32 v3, v4, 1, v3
    s_add_u32 s45, s26, 32768
    buffer_load_ushort v16, v3, s[28:31], 0 offen offset:0
    buffer_load_ushort v17, v3, s[28:31], 0 offen offset:256
    buffer_load_ushort v18, v3, s[28:31], 0 offen offset:512
    buffer_load_ushort v19, v3, s[28:31], 0 offen offset:768
    buffer_load_ushort v20, v3, s[28:31], 0 offen offset:1024
    buffer_load_ushort v21, v3, s[28:31], 0 offen offset:1280
    buffer_load_ushort v22, v3, s[28:31], 0 offen offset:1536
    buffer_load_ushort v23, v3, s[28:31], 0 offen offset:1792
    s_branch K1_pr1d
K1_pr1x:
    s_mov_b32 s45, 0x7fffff00
    s_mov_b32 s41, 1.0
K1_pr1d:
    s_add_u32 s38, s27, 4096
    s_cmp_ge_u32 s38, 6400
    s_cbranch_scc1 K1_pr2x
    s_cmp_ge_u32 s38, 2304
    s_cbranch_scc1 K1_pr2h
    s_lshr_b32 s12, s38, 8
    s_lshl_b32 s13, s12, 4
    s_cmp_eq_u32 s12, 8
    s_cselect_b32 s13, 257, s13
    s_cselect_b32 s42, 0xbfb8aa3b, 1.0
    s_cselect_b32 s25, 32768, 0
    s_lshr_b32 s15, s38, 6
    s_and_b32 s15, s15, 3
    s_lshl_b32 s15, s15, 5
    v_lshrrev_b32 v3, 5, v2
    v_lshlrev_b32 v3, 3, v3
    v_add_u32 v3, s13, v3
    v_and_b32 v4, 31, v2
    v_add_u32 v4, s15, v4
    v_lshlrev_b32 v3, 8, v3
    v_lshl_add_u32 v3, v4, 1, v3
    s_add_u32 s46, s25, s26
    buffer_load_ushort v24, v3, s[16:19], 0 offen offset:0
    buffer_load_ushort v25, v3, s[16:19], 0 offen offset:256
    buffer_load_ushort v26, v3, s[16:19], 0 offen offset:512
    buffer_load_ushort v27, v3, s[16:19], 0 offen offset:768
    buffer_load_ushort v28, v3, s[16:19], 0 offen offset:1024
    buffer_load_ushort v29, v3, s[16:19], 0 offen offset:1280
    buffer_load_ushort v30, v3, s[16:19], 0 offen offset:1536
    buffer_load_ushort v31, v3, s[16:19], 0 offen offset:1792
    s_branch K1_pr2d
K1_pr2h:
    s_sub_u32 s12, s38, 2304
    s_lshr_b32 s13, s12, 6
    s_and_b32 s13, s13, 7
    s_lshl_b32 s13, s13, 5
    s_lshr_b32 s15, s12, 9
    s_lshl_b32 s15, s15, 4
    s_mov_b32 s42, 1.0
    v_lshrrev_b32 v3, 4, v2
    v_lshlrev_b32 v3, 3, v3
    v_add_u32 v3, s13, v3
    v_and_b32 v4, 15, v2
    v_add_u32 v4, s15, v4
    v_lshlrev_b32 v3, 8, v3
    v_lshl_add_u32 v3, v4, 1, v3
    s_add_u32 s46, s26, 32768
    buffer_load_ushort v24, v3, s[28:31], 0 offen offset:0
    buffer_load_ushort v25, v3, s[28:31], 0 offen offset:256
    buffer_load_ushort v26, v3, s[28:31], 0 offen offset:512
    buffer_load_ushort v27, v3, s[28:31], 0 offen offset:768
    buffer_load_ushort v28, v3, s[28:31], 0 offen offset:1024
    buffer_load_ushort v29, v3, s[28:31], 0 offen offset:1280
    buffer_load_ushort v30, v3, s[28:31], 0 offen offset:1536
    buffer_load_ushort v31, v3, s[28:31], 0 offen offset:1792
    s_branch K1_pr2d
K1_pr2x:
    s_mov_b32 s46, 0x7fffff00
    s_mov_b32 s42, 1.0
K1_pr2d:
    s_add_u32 s39, s27, 6144
    s_cmp_ge_u32 s39, 6400
    s_cbranch_scc1 K1_pr3x
    s_cmp_ge_u32 s39, 2304
    s_cbranch_scc1 K1_pr3h
    s_lshr_b32 s12, s39, 8
    s_lshl_b32 s13, s12, 4
    s_cmp_eq_u32 s12, 8
    s_cselect_b32 s13, 257, s13
    s_cselect_b32 s43, 0xbfb8aa3b, 1.0
    s_cselect_b32 s25, 32768, 0
    s_lshr_b32 s15, s39, 6
    s_and_b32 s15, s15, 3
    s_lshl_b32 s15, s15, 5
    v_lshrrev_b32 v3, 5, v2
    v_lshlrev_b32 v3, 3, v3
    v_add_u32 v3, s13, v3
    v_and_b32 v4, 31, v2
    v_add_u32 v4, s15, v4
    v_lshlrev_b32 v3, 8, v3
    v_lshl_add_u32 v3, v4, 1, v3
    s_add_u32 s47, s25, s26
    buffer_load_ushort v32, v3, s[16:19], 0 offen offset:0
    buffer_load_ushort v33, v3, s[16:19], 0 offen offset:256
    buffer_load_ushort v34, v3, s[16:19], 0 offen offset:512
    buffer_load_ushort v35, v3, s[16:19], 0 offen offset:768
    buffer_load_ushort v36, v3, s[16:19], 0 offen offset:1024
    buffer_load_ushort v37, v3, s[16:19], 0 offen offset:1280
    buffer_load_ushort v38, v3, s[16:19], 0 offen offset:1536
    buffer_load_ushort v39, v3, s[16:19], 0 offen offset:1792
    s_branch K1_pr3d
K1_pr3h:
    s_sub_u32 s12, s39, 2304
    s_lshr_b32 s13, s12, 6
    s_and_b32 s13, s13, 7
    s_lshl_b32 s13, s13, 5
    s_lshr_b32 s15, s12, 9
    s_lshl_b32 s15, s15, 4
    s_mov_b32 s43, 1.0
    v_lshrrev_b32 v3, 4, v2
    v_lshlrev_b32 v3, 3, v3
    v_add_u32 v3, s13, v3
    v_and_b32 v4, 15, v2
    v_add_u32 v4, s15, v4
    v_lshlrev_b32 v3, 8, v3
    v_lshl_add_u32 v3, v4, 1, v3
    s_add_u32 s47, s26, 32768
    buffer_load_ushort v32, v3, s[28:31], 0 offen offset:0
    buffer_load_ushort v33, v3, s[28:31], 0 offen offset:256
    buffer_load_ushort v34, v3, s[28:31], 0 offen offset:512
    buffer_load_ushort v35, v3, s[28:31], 0 offen offset:768
    buffer_load_ushort v36, v3, s[28:31], 0 offen offset:1024
    buffer_load_ushort v37, v3, s[28:31], 0 offen offset:1280
    buffer_load_ushort v38, v3, s[28:31], 0 offen offset:1536
    buffer_load_ushort v39, v3, s[28:31], 0 offen offset:1792
    s_branch K1_pr3d
K1_pr3x:
    s_mov_b32 s47, 0x7fffff00
    s_mov_b32 s43, 1.0
K1_pr3d:
    s_waitcnt vmcnt(0)
    v_lshlrev_b32 v8, 16, v8
    v_lshlrev_b32 v9, 16, v9
    v_lshlrev_b32 v10, 16, v10
    v_lshlrev_b32 v11, 16, v11
    v_lshlrev_b32 v12, 16, v12
    v_lshlrev_b32 v13, 16, v13
    v_lshlrev_b32 v14, 16, v14
    v_lshlrev_b32 v15, 16, v15
    v_mul_f32 v8, s40, v8
    v_mul_f32 v9, s40, v9
    v_mul_f32 v10, s40, v10
    v_mul_f32 v11, s40, v11
    v_mul_f32 v12, s40, v12
    v_mul_f32 v13, s40, v13
    v_mul_f32 v14, s40, v14
    v_mul_f32 v15, s40, v15
    v_cvt_pk_bf16_f32 v44, v8, v9
    v_cvt_pk_bf16_f32 v45, v10, v11
    v_cvt_pk_bf16_f32 v46, v12, v13
    v_cvt_pk_bf16_f32 v47, v14, v15
    s_lshl_b32 s12, s36, 4
    v_lshlrev_b32 v3, 4, v2
    v_add_u32 v60, s12, v3
    buffer_store_dwordx4 v[44:47], v60, s[20:23], s44 offen
    v_lshlrev_b32 v16, 16, v16
    v_lshlrev_b32 v17, 16, v17
    v_lshlrev_b32 v18, 16, v18
    v_lshlrev_b32 v19, 16, v19
    v_lshlrev_b32 v20, 16, v20
    v_lshlrev_b32 v21, 16, v21
    v_lshlrev_b32 v22, 16, v22
    v_lshlrev_b32 v23, 16, v23
    v_mul_f32 v16, s41, v16
    v_mul_f32 v17, s41, v17
    v_mul_f32 v18, s41, v18
    v_mul_f32 v19, s41, v19
    v_mul_f32 v20, s41, v20
    v_mul_f32 v21, s41, v21
    v_mul_f32 v22, s41, v22
    v_mul_f32 v23, s41, v23
    v_cvt_pk_bf16_f32 v48, v16, v17
    v_cvt_pk_bf16_f32 v49, v18, v19
    v_cvt_pk_bf16_f32 v50, v20, v21
    v_cvt_pk_bf16_f32 v51, v22, v23
    s_lshl_b32 s12, s37, 4
    v_lshlrev_b32 v3, 4, v2
    v_add_u32 v61, s12, v3
    buffer_store_dwordx4 v[48:51], v61, s[20:23], s45 offen
    v_lshlrev_b32 v24, 16, v24
    v_lshlrev_b32 v25, 16, v25
    v_lshlrev_b32 v26, 16, v26
    v_lshlrev_b32 v27, 16, v27
    v_lshlrev_b32 v28, 16, v28
    v_lshlrev_b32 v29, 16, v29
    v_lshlrev_b32 v30, 16, v30
    v_lshlrev_b32 v31, 16, v31
    v_mul_f32 v24, s42, v24
    v_mul_f32 v25, s42, v25
    v_mul_f32 v26, s42, v26
    v_mul_f32 v27, s42, v27
    v_mul_f32 v28, s42, v28
    v_mul_f32 v29, s42, v29
    v_mul_f32 v30, s42, v30
    v_mul_f32 v31, s42, v31
    v_cvt_pk_bf16_f32 v52, v24, v25
    v_cvt_pk_bf16_f32 v53, v26, v27
    v_cvt_pk_bf16_f32 v54, v28, v29
    v_cvt_pk_bf16_f32 v55, v30, v31
    s_lshl_b32 s12, s38, 4
    v_lshlrev_b32 v3, 4, v2
    v_add_u32 v62, s12, v3
    buffer_store_dwordx4 v[52:55], v62, s[20:23], s46 offen
    v_lshlrev_b32 v32, 16, v32
    v_lshlrev_b32 v33, 16, v33
    v_lshlrev_b32 v34, 16, v34
    v_lshlrev_b32 v35, 16, v35
    v_lshlrev_b32 v36, 16, v36
    v_lshlrev_b32 v37, 16, v37
    v_lshlrev_b32 v38, 16, v38
    v_lshlrev_b32 v39, 16, v39
    v_mul_f32 v32, s43, v32
    v_mul_f32 v33, s43, v33
    v_mul_f32 v34, s43, v34
    v_mul_f32 v35, s43, v35
    v_mul_f32 v36, s43, v36
    v_mul_f32 v37, s43, v37
    v_mul_f32 v38, s43, v38
    v_mul_f32 v39, s43, v39
    v_cvt_pk_bf16_f32 v56, v32, v33
    v_cvt_pk_bf16_f32 v57, v34, v35
    v_cvt_pk_bf16_f32 v58, v36, v37
    v_cvt_pk_bf16_f32 v59, v38, v39
    s_lshl_b32 s12, s39, 4
    v_lshlrev_b32 v3, 4, v2
    v_add_u32 v63, s12, v3
    buffer_store_dwordx4 v[56:59], v63, s[20:23], s47 offen
    s_endpgm
K1_pref:
    v_lshlrev_b32 v1, 7, v0
    s_getpc_b64 s[24:25]
K1_pc:
    s_add_u32 s24, s24, k2_kernel-K1_pc
    s_addc_u32 s25, s25, 0
    v_cmp_gt_u32 vcc, (K2_end-k2_kernel+127)/128, v0
    s_and_saveexec_b64 s[28:29], vcc
    s_cbranch_execz K1_pfend
    global_load_dword v4, v1, s[24:25]
K1_pfend:
    s_endpgm
K1_done:
    s_endpgm
.globl k2_kernel
.p2align 8
.type k2_kernel,@function
k2_kernel:
    s_cmp_ge_u32 s2, 250
    s_cbranch_scc1 K2_done
    s_load_dwordx2 s[20:21], s[0:1], 80
    s_load_dwordx2 s[76:77], s[0:1], 0
    s_load_dwordx2 s[16:17], s[0:1], 8
    s_load_dwordx2 s[28:29], s[0:1], 40
    s_load_dwordx2 s[12:13], s[0:1], 16
    s_load_dwordx2 s[24:25], s[0:1], 64
    s_load_dwordx2 s[72:73], s[0:1], 48
    v_and_b32 v246, 63, v0
    v_lshrrev_b32 v248, 6, v0
    v_lshlrev_b32 v249, 4, v0
    v_readfirstlane_b32 s32, v248
    s_mul_i32 s35, s2, 40
    s_lshl_b32 s61, s2, 13
    s_mov_b32 s22, 5836800
    s_mov_b32 s23, 0x00020000
    s_mov_b32 s78, 10000
    s_mov_b32 s79, 0x00020000
    s_mov_b32 s18, 60004
    s_mov_b32 s19, 0x00020000
    s_lshr_b32 s33, s32, 2
    s_and_b32 s34, s32, 3
    v_lshrrev_b32 v248, 4, v246
    v_and_b32 v250, 15, v246
    v_xor_b32 v250, v250, v248
    v_lshlrev_b32 v33, 4, v250
    v_mov_b32 v35, v33
    s_min_u32 s64, s32, 6
    s_lshl_b32 s62, s64, 3
    s_add_u32 s62, s62, s35
    v_add_u32 v32, s62, v248
    v_add_u32 v34, 4, v32
    s_mul_i32 s63, s64, 2176
    s_add_u32 s63, s63, 49152
    v_lshlrev_b32 v36, 4, v246
    v_mul_u32_u24 v37, 6, v0
    v_and_b32 v38, 31, v246
    s_lshl_b32 s65, s34, 5
    v_add_u32 v38, s65, v38
    v_lshlrev_b32 v38, 1, v38
    s_mul_i32 s65, s2, 240
    s_lshl_b32 s66, s32, 12
    s_and_b32 s68, s2, 7
    s_mul_i32 s68, s68, 139264
    s_add_u32 s68, s68, 2097152
    s_waitcnt lgkmcnt(0)
    buffer_load_dwordx4 v[168:171], v249, s[20:23], s61 offen
    s_add_u32 s8, s20, 3276800
    s_addc_u32 s9, s21, 0
    s_or_b32 s9, s9, 0x1000000
    s_mov_b32 s10, 10000
    s_mov_b32 s11, 0x00020000
    s_or_b32 s13, s13, 0x200000
    s_mov_b32 s14, 160000
    s_mov_b32 s15, 0x00020000
    s_mov_b32 s26, 2620000
    s_mov_b32 s27, 0x00020000
    s_mov_b32 s58, 0
    s_mov_b32 s60, 1
    s_mov_b32 s74, 0
    s_mov_b32 s75, 160000
    s_mov_b32 s70, 0
    s_add_u32 s88, s20, 3275776
    s_addc_u32 s89, s21, 0
    s_or_b32 s89, s89, 0x1000000
    s_mov_b32 s90, 10000
    s_mov_b32 s91, 0x00020000
    s_or_b32 s77, s77, 0x1000000
    s_mov_b32 s30, 69888
    s_mov_b32 s31, 0x00020000
    s_lshl_b32 s3, s32, 11
    v_mov_b32 v224, 0
    v_mov_b32 v225, 0
    v_mov_b32 v226, 0
    v_mov_b32 v227, 0
    s_cmp_eq_u32 s33, 0
    s_cbranch_scc0 K2_L
    s_mov_b32 m0, s63
    s_add_u32 s63, s63, 1088
    buffer_load_dwordx4 v[32:33], s[76:79], 0 idxen offen lds
    s_mov_b32 m0, s63
    s_add_u32 s71, s66, s68
    buffer_load_dwordx4 v[34:35], s[76:79], 0 idxen offen lds
    s_add_u32 m0, s66, 0
    s_nop 0
    buffer_load_dwordx4 v36, s[20:23], s71 offen lds
    s_add_u32 m0, s66, 1024
    s_add_u32 s71, s71, 1024
    buffer_load_dwordx4 v36, s[20:23], s71 offen lds
    s_add_u32 m0, s66, 2048
    s_add_u32 s71, s71, 1024
    buffer_load_dwordx4 v36, s[20:23], s71 offen lds
    s_add_u32 m0, s66, 3072
    s_add_u32 s71, s71, 1024
    buffer_load_dwordx4 v36, s[20:23], s71 offen lds
    s_lshl_b32 s71, s34, 10
    s_add_u32 m0, s71, 32768
    s_add_u32 s71, s71, s68
    s_add_u32 s71, s71, 65536
    buffer_load_dwordx4 v36, s[20:23], s71 offen lds
    buffer_load_dwordx2 v[188:189], v37, s[16:19], s65 offen
    s_mov_b32 s63, 65536
    buffer_load_ushort v31, v38, s[28:31], s63 offen
    s_lshl_b32 s71, s32, 13
    s_add_u32 s71, s71, s68
    s_add_u32 s71, s71, 69632
    buffer_load_dwordx4 v[48:51], v36, s[20:23], s71 offen offset:0
    buffer_load_dwordx4 v[52:55], v36, s[20:23], s71 offen offset:1024
    buffer_load_dwordx4 v[56:59], v36, s[20:23], s71 offen offset:2048
    buffer_load_dwordx4 v[60:63], v36, s[20:23], s71 offen offset:3072
K2_L:
    v_lshlrev_b32 v249, 4, v0
    v_add_u32 v249, 65536, v249
    ds_write_b128 v249, v[224:227] offset:0
    v_and_b32 v248, 31, v246
    v_lshrrev_b32 v250, 5, v246
    v_mul_u32_u24 v253, 13824, v250
    v_lshl_add_u32 v242, v248, 4, v253
    v_add_u32 v242, 120832, v242
    v_lshlrev_b32 v243, 8, v250
    ds_write_b128 v249, v[224:227] offset:8192
    v_bfe_u32 v253, v246, 4, 1
    v_lshl_add_u32 v243, v253, 5, v243
    v_bfe_u32 v253, v246, 2, 2
    v_lshl_add_u32 v243, v253, 6, v243
    v_and_b32 v253, 3, v246
    v_lshl_add_u32 v243, v253, 3, v243
    ds_write_b128 v249, v[224:227] offset:16384
    v_lshl_add_u32 v240, v250, 8, v243
    v_add_u32 v240, s3, v240
    v_add_u32 v243, 65536, v243
    v_lshrrev_b32 v253, 2, v246
    v_lshlrev_b32 v253, 3, v253
    v_add_u32 v244, 148480, v253
    ds_write_b128 v249, v[224:227] offset:24576
    v_lshlrev_b32 v253, 3, v248
    v_add_u32 v245, 148480, v253
    v_and_b32 v253, 3, v246
    v_lshlrev_b32 v253, 4, v253
    s_lshl_b32 s64, s34, 6
    v_add_u32 v235, s64, v253
    ds_write_b128 v249, v[224:227] offset:32768
    v_mov_b32 v237, v235
    v_lshlrev_b32 v239, 4, v250
    v_bfe_u32 v253, v246, 2, 2
    v_mul_u32_u24 v241, 1088, v253
    v_and_b32 v253, 3, v246
    v_lshl_add_u32 v241, v253, 8, v241
    ds_write_b128 v249, v[224:227] offset:40960
    v_lshrrev_b32 v252, 4, v246
    v_xor_b32 v253, v253, v252
    v_lshl_add_u32 v241, v253, 4, v241
    v_add_u32 v241, 49152, v241
    v_and_b32 v253, 1, v248
    v_lshlrev_b32 v253, 4, v253
    ds_write_b128 v249, v[224:227] offset:49152
    v_mov_b32 v252, 0x3f80
    v_lshlrev_b32 v252, v253, v252
    v_bfe_u32 v253, v248, 1, 2
    v_lshrrev_b32 v15, 4, v248
    v_lshl_add_u32 v253, v15, 2, v253
    v_bfe_u32 v15, v248, 3, 1
    ds_write_b128 v249, v[224:227] offset:57344
    v_cmp_eq_u32 vcc, v15, v250
    s_nop 1
    v_cndmask_b32 v253, 15, v253, vcc
    v_cmp_eq_u32 s[36:37], 0, v253
    v_cmp_eq_u32 s[38:39], 1, v253
    v_cmp_eq_u32 s[40:41], 2, v253
    v_add_u32 v249, 65536, v249
    ds_write_b128 v249, v[224:227] offset:0
    v_cmp_eq_u32 s[42:43], 3, v253
    v_cmp_eq_u32 s[44:45], 4, v253
    v_cmp_eq_u32 s[46:47], 5, v253
    v_cmp_eq_u32 s[48:49], 6, v253
    v_cmp_eq_u32 s[50:51], 7, v253
    v_cndmask_b32 v8, 0, v252, s[36:37]
    ds_write_b128 v249, v[224:227] offset:8192
    v_cndmask_b32 v9, 0, v252, s[38:39]
    v_cndmask_b32 v10, 0, v252, s[40:41]
    v_cndmask_b32 v11, 0, v252, s[42:43]
    v_cndmask_b32 v12, 0, v252, s[44:45]
    v_cndmask_b32 v13, 0, v252, s[46:47]
    v_cndmask_b32 v14, 0, v252, s[48:49]
    ds_write_b128 v249, v[224:227] offset:16384
    v_cndmask_b32 v15, 0, v252, s[50:51]
    v_cmp_gt_u32 vcc, 480, v0
    s_and_saveexec_b64 s[4:5], vcc
    ds_write_b128 v249, v[224:227] offset:24576
    s_mov_b64 exec, s[4:5]
    s_cmp_eq_u32 s33, 0
    s_cbranch_scc1 K2_VLd
    s_mov_b32 m0, s63
    s_add_u32 s63, s63, 1088
    buffer_load_dwordx4 v[32:33], s[76:79], 0 idxen offen lds
    s_mov_b32 m0, s63
    s_add_u32 s71, s66, s68
    buffer_load_dwordx4 v[34:35], s[76:79], 0 idxen offen lds
    s_add_u32 m0, s66, 0
    s_nop 0
    buffer_load_dwordx4 v36, s[20:23], s71 offen lds
    s_add_u32 m0, s66, 1024
    s_add_u32 s71, s71, 1024
    buffer_load_dwordx4 v36, s[20:23], s71 offen lds
    s_add_u32 m0, s66, 2048
    s_add_u32 s71, s71, 1024
    buffer_load_dwordx4 v36, s[20:23], s71 offen lds
    s_add_u32 m0, s66, 3072
    s_add_u32 s71, s71, 1024
    buffer_load_dwordx4 v36, s[20:23], s71 offen lds
    s_lshl_b32 s71, s34, 10
    s_add_u32 m0, s71, 32768
    s_add_u32 s71, s71, s68
    s_add_u32 s71, s71, 65536
    buffer_load_dwordx4 v36, s[20:23], s71 offen lds
    buffer_load_dwordx2 v[188:189], v37, s[16:19], s65 offen
    s_mov_b32 s63, 65536
    buffer_load_ushort v31, v38, s[28:31], s63 offen
    s_lshl_b32 s71, s32, 13
    s_add_u32 s71, s71, s68
    s_add_u32 s71, s71, 69632
    buffer_load_dwordx4 v[48:51], v36, s[20:23], s71 offen offset:0
    buffer_load_dwordx4 v[52:55], v36, s[20:23], s71 offen offset:1024
    buffer_load_dwordx4 v[56:59], v36, s[20:23], s71 offen offset:2048
    buffer_load_dwordx4 v[60:63], v36, s[20:23], s71 offen offset:3072
K2_VLd:
    s_waitcnt lgkmcnt(0)
    s_barrier
    s_branch K2_fast
K2_zero:
    v_lshlrev_b32 v249, 4, v0
    v_add_u32 v249, 65536, v249
    ds_write_b128 v249, v[224:227] offset:0
    ds_write_b128 v249, v[224:227] offset:8192
    ds_write_b128 v249, v[224:227] offset:16384
    ds_write_b128 v249, v[224:227] offset:24576
    ds_write_b128 v249, v[224:227] offset:32768
    ds_write_b128 v249, v[224:227] offset:40960
    ds_write_b128 v249, v[224:227] offset:49152
    ds_write_b128 v249, v[224:227] offset:57344
    v_add_u32 v249, 65536, v249
    ds_write_b128 v249, v[224:227] offset:0
    ds_write_b128 v249, v[224:227] offset:8192
    ds_write_b128 v249, v[224:227] offset:16384
    v_cmp_gt_u32 vcc, 480, v0
    s_and_saveexec_b64 s[4:5], vcc
    ds_write_b128 v249, v[224:227] offset:24576
    s_mov_b64 exec, s[4:5]
    s_waitcnt lgkmcnt(0)
    s_barrier
    s_mul_i32 s61, s59, 192
    s_add_u32 s59, s59, 1
    v_add_u32 v253, s61, v0
    v_lshlrev_b32 v248, 2, v253
    s_load_dwordx2 s[28:29], s[0:1], 24
    s_mov_b32 s30, 640000
    s_waitcnt lgkmcnt(0)
    buffer_load_dword v169, v248, s[28:31], 0 offen
    s_waitcnt vmcnt(0)
    s_load_dwordx2 s[28:29], s[0:1], 32
    s_waitcnt lgkmcnt(0)
    buffer_load_dword v170, v248, s[28:31], 0 offen
    s_waitcnt vmcnt(0)
    v_subrev_u32 v170, s35, v170
    v_lshl_or_b32 v168, v170, 14, v169
    v_cmp_gt_u32 vcc, 40, v170
    s_movk_i32 s61, 192
    v_cmp_gt_u32 s[4:5], s61, v0
    s_and_b64 vcc, vcc, s[4:5]
    s_mov_b32 s61, 160000
    v_cmp_gt_u32 s[4:5], s61, v253
    s_and_b64 vcc, vcc, s[4:5]
    s_nop 1
    v_cndmask_b32 v168, -1, v168, vcc
    v_mov_b32 v169, -1
    v_mov_b32 v170, -1
    v_mov_b32 v171, -1
    s_branch K2_rank
K2_fast:
    v_lshrrev_b32 v253, 3, v0
    v_mul_u32_u24 v253, 2500, v253
    s_waitcnt vmcnt(0)
    v_cmp_gt_u32 vcc, 48, v0
    s_and_saveexec_b64 s[4:5], vcc
    v_lshlrev_b32 v249, 3, v0
    v_add_u32 v249, 163328, v249
    ds_write_b64 v249, v[188:189]
    s_mov_b64 exec, s[4:5]
    v_cmp_eq_u32 vcc, -2, v168
    s_cbranch_vccnz K2_mark
K2_rank:
    v_mov_b32 v248, 1
    v_cmp_gt_u32 vcc, -2, v168
    s_and_saveexec_b64 s[4:5], vcc
    s_cbranch_execz K2_rk0
    v_bfe_u32 v184, v168, 17, 3
    v_and_b32 v249, 0x3fff, v168
    v_lshlrev_b32 v250, 2, v184
    v_mul_u32_u24 v249, 6, v249
    v_add_u32 v250, 157184, v250
    ds_add_rtn_u32 v172, v250, v248
    buffer_load_dwordx2 v[112:113], v249, s[16:19], 0 offen
K2_rk0:
    s_mov_b64 exec, s[4:5]
    v_cmp_gt_u32 vcc, -2, v169
    s_and_saveexec_b64 s[4:5], vcc
    s_cbranch_execz K2_rk1
    v_bfe_u32 v185, v169, 17, 3
    v_and_b32 v249, 0x3fff, v169
    v_lshlrev_b32 v250, 2, v185
    v_mul_u32_u24 v249, 6, v249
    v_add_u32 v250, 157184, v250
    ds_add_rtn_u32 v173, v250, v248
    buffer_load_dwordx2 v[114:115], v249, s[16:19], 0 offen
K2_rk1:
    s_mov_b64 exec, s[4:5]
    v_cmp_gt_u32 vcc, -2, v170
    s_and_saveexec_b64 s[4:5], vcc
    s_cbranch_execz K2_rk2
    v_bfe_u32 v186, v170, 17, 3
    v_and_b32 v249, 0x3fff, v170
    v_lshlrev_b32 v250, 2, v186
    v_mul_u32_u24 v249, 6, v249
    v_add_u32 v250, 157184, v250
    ds_add_rtn_u32 v174, v250, v248
    buffer_load_dwordx2 v[116:117], v249, s[16:19], 0 offen
K2_rk2:
    s_mov_b64 exec, s[4:5]
    v_cmp_gt_u32 vcc, -2, v171
    s_and_saveexec_b64 s[4:5], vcc
    s_cbranch_execz K2_rk3
    v_bfe_u32 v187, v171, 17, 3
    v_and_b32 v249, 0x3fff, v171
    v_lshlrev_b32 v250, 2, v187
    v_mul_u32_u24 v249, 6, v249
    v_add_u32 v250, 157184, v250
    ds_add_rtn_u32 v175, v250, v248
    buffer_load_dwordx2 v[118:119], v249, s[16:19], 0 offen
K2_rk3:
    s_mov_b64 exec, s[4:5]
    s_waitcnt lgkmcnt(0)
    s_barrier
    v_mov_b32 v249, 157184
    ds_read_b128 v[176:179], v249
    ds_read_b64 v[180:181], v249 offset:16
    v_bfe_u32 v250, v168, 14, 6
    v_lshlrev_b32 v250, 3, v250
    v_add_u32 v250, 163328, v250
    ds_read_b64 v[120:121], v250
    v_bfe_u32 v250, v169, 14, 6
    v_lshlrev_b32 v250, 3, v250
    v_add_u32 v250, 163328, v250
    ds_read_b64 v[122:123], v250
    v_bfe_u32 v250, v170, 14, 6
    v_lshlrev_b32 v250, 3, v250
    v_add_u32 v250, 163328, v250
    ds_read_b64 v[124:125], v250
    v_bfe_u32 v250, v171, 14, 6
    v_lshlrev_b32 v250, 3, v250
    v_add_u32 v250, 163328, v250
    ds_read_b64 v[126:127], v250
    s_waitcnt lgkmcnt(4)
    v_readfirstlane_b32 s36, v176
    v_readfirstlane_b32 s37, v177
    v_readfirstlane_b32 s38, v178
    v_readfirstlane_b32 s39, v179
    v_readfirstlane_b32 s40, v180
    v_readfirstlane_b32 s41, v181
    s_cmp_eq_u32 s60, 0
    s_cbranch_scc1 K2_nowf
    v_lshlrev_b32 v250, 4, v246
    s_lshl_b32 s66, s34, 10
    v_add_u32 v250, s66, v250
    ds_read_b128 v[64:67], v250 offset:0
    ds_read_b128 v[68:71], v250 offset:4096
    ds_read_b128 v[72:75], v250 offset:8192
    ds_read_b128 v[76:79], v250 offset:12288
    ds_read_b128 v[80:83], v250 offset:16384
    ds_read_b128 v[84:87], v250 offset:20480
    ds_read_b128 v[88:91], v250 offset:24576
    ds_read_b128 v[92:95], v250 offset:28672
    ds_read_b128 v[4:7], v250 offset:32768
K2_nowf:
    s_add_u32 s61, s36, 31
    s_lshr_b32 s61, s61, 5
    s_add_u32 s62, s37, 31
    s_lshr_b32 s62, s62, 5
    s_add_u32 s63, s38, 31
    s_lshr_b32 s63, s63, 5
    s_add_u32 s64, s39, 31
    s_lshr_b32 s64, s64, 5
    s_add_u32 s65, s40, 31
    s_lshr_b32 s65, s65, 5
    s_add_u32 s4, s61, s62
    s_add_u32 s5, s4, s63
    s_add_u32 s6, s5, s64
    s_add_u32 s7, s6, s65
    s_cmp_gt_u32 s7, 27
    s_cselect_b32 s66, 1, 0
    s_or_b32 s66, s66, s41
    s_cmp_lg_u32 s66, 0
    s_cbranch_scc1 K2_toslow
    s_lshl_b32 s67, s61, 5
    s_lshl_b32 s66, s4, 10
    s_or_b32 s67, s67, s66
    s_lshl_b32 s66, s5, 15
    s_or_b32 s67, s67, s66
    s_lshl_b32 s66, s6, 20
    s_or_b32 s67, s67, s66
    v_cmp_gt_u32 vcc, -2, v168
    s_and_saveexec_b64 s[84:85], vcc
    s_cbranch_execz K2_rw0
    v_mul_u32_u24 v248, 5, v184
    v_bfe_u32 v248, s67, v248, 5
    v_lshl_add_u32 v172, v248, 5, v172
    v_lshlrev_b32 v248, 3, v172
    v_and_b32 v250, 0x3fff, v168
    v_lshrrev_b32 v251, 20, v168
    v_add_u32 v251, v251, v253
    v_add_u32 v248, 148480, v248
    ds_write_b64 v248, v[250:251]
K2_rw0:
    s_mov_b64 exec, s[84:85]
    v_cmp_gt_u32 vcc, -2, v169
    s_and_saveexec_b64 s[84:85], vcc
    s_cbranch_execz K2_rw1
    v_mul_u32_u24 v248, 5, v185
    v_bfe_u32 v248, s67, v248, 5
    v_lshl_add_u32 v173, v248, 5, v173
    v_lshlrev_b32 v248, 3, v173
    v_and_b32 v250, 0x3fff, v169
    v_lshrrev_b32 v251, 20, v169
    v_add_u32 v251, v251, v253
    v_add_u32 v248, 148480, v248
    ds_write_b64 v248, v[250:251]
K2_rw1:
    s_mov_b64 exec, s[84:85]
    v_cmp_gt_u32 vcc, -2, v170
    s_and_saveexec_b64 s[84:85], vcc
    s_cbranch_execz K2_rw2
    v_mul_u32_u24 v248, 5, v186
    v_bfe_u32 v248, s67, v248, 5
    v_lshl_add_u32 v174, v248, 5, v174
    v_lshlrev_b32 v248, 3, v174
    v_and_b32 v250, 0x3fff, v170
    v_lshrrev_b32 v251, 20, v170
    v_add_u32 v251, v251, v253
    v_add_u32 v248, 148480, v248
    ds_write_b64 v248, v[250:251]
K2_rw2:
    s_mov_b64 exec, s[84:85]
    v_cmp_gt_u32 vcc, -2, v171
    s_and_saveexec_b64 s[84:85], vcc
    s_cbranch_execz K2_rw3
    v_mul_u32_u24 v248, 5, v187
    v_bfe_u32 v248, s67, v248, 5
    v_lshl_add_u32 v175, v248, 5, v175
    v_lshlrev_b32 v248, 3, v175
    v_and_b32 v250, 0x3fff, v171
    v_lshrrev_b32 v251, 20, v171
    v_add_u32 v251, v251, v253
    v_add_u32 v248, 148480, v248
    ds_write_b64 v248, v[250:251]
K2_rw3:
    s_mov_b64 exec, s[84:85]
    s_add_u32 s66, s7, 1
    s_lshr_b32 s66, s66, 1
    s_max_u32 s66, s66, s4
    s_min_u32 s66, s66, s5
    s_sub_u32 s64, s7, s66
    s_cmp_eq_u32 s33, 0
    s_cselect_b32 s43, 0, s66
    s_cselect_b32 s42, s66, s64
    s_cselect_b32 s46, s61, s5
    s_cselect_b32 s47, s4, s6
    s_sub_u32 s46, s46, s43
    s_sub_u32 s47, s47, s43
    s_mov_b32 s49, s46
    s_mov_b32 s50, s47
    s_mov_b32 s48, 0
    s_mov_b32 s51, 0
    s_sub_u32 s92, s42, 1
    s_sub_u32 s93, s92, s46
    s_cmp_eq_u32 s58, 0
    s_cbranch_scc0 K2_readdr
K2_addrok:
    s_lshl_b32 s61, s43, 9
    v_add_u32 v242, s61, v242
    s_lshl_b32 s61, s43, 11
    v_add_u32 v243, s61, v243
    s_lshl_b32 s61, s43, 8
    v_add_u32 v244, s61, v244
    v_add_u32 v245, s61, v245
    s_waitcnt lgkmcnt(0)
    s_barrier
    ds_read_u16 v32, v244 offset:0
    ds_read_u16 v34, v244 offset:128
    ds_read_b32 v36, v245 offset:4
    ds_read_u16 v200, v244 offset:256
    ds_read_u16 v202, v244 offset:384
    ds_read_b32 v204, v245 offset:260
    ds_read_u16 v206, v244 offset:512
    ds_read_u16 v208, v244 offset:640
    ds_read_b32 v210, v245 offset:516
    ds_read_u16 v234, v244 offset:768
    ds_read_u16 v236, v244 offset:896
    ds_read_b32 v238, v245 offset:772
    v_mov_b32 v33, v235
    v_mov_b32 v35, v235
    v_mov_b32 v37, v239
    v_mov_b32 v201, v235
    v_mov_b32 v203, v235
    v_mov_b32 v205, v239
    v_mov_b32 v207, v235
    v_mov_b32 v209, v235
    v_mov_b32 v211, v239
    s_waitcnt lgkmcnt(9)
    s_add_u32 m0, s3, 0
    s_nop 0
    buffer_load_dwordx4 v[32:33], s[8:11], 0 idxen offen lds
    buffer_load_dwordx4 v[34:35], s[88:91], 0 idxen offen offset:1024 lds
    buffer_load_dwordx4 v[148:151], v[36:37], s[12:15], 0 idxen offen
    s_cmp_eq_u32 s60, 0
    s_cbranch_scc1 K2_noX
    s_mov_b32 s60, 0
    v_and_b32 v248, 31, v246
    s_lshl_b32 s61, s33, 4
    v_add_u32 v248, s61, v248
    v_lshrrev_b32 v249, 2, v248
    v_mul_u32_u24 v249, 1088, v249
    v_and_b32 v252, 3, v248
    v_lshl_add_u32 v249, v252, 8, v249
    v_add_u32 v249, 49152, v249
    v_lshrrev_b32 v253, 5, v246
    v_xor_b32 v253, v253, v252
    v_lshl_add_u32 v248, v253, 4, v249
    v_xor_b32 v253, 2, v253
    v_lshl_add_u32 v249, v253, 4, v249
    s_waitcnt lgkmcnt(0)
    ds_read_b128 v[140:143], v248 offset:0
    ds_read_b128 v[144:147], v249 offset:0
    ds_read_b128 v[164:167], v248 offset:64
    ds_read_b128 v[176:179], v249 offset:64
    s_waitcnt lgkmcnt(3)
    v_mfma_f32_32x32x16_bf16 v[32:47], v[140:143], v[64:67], 0
    s_waitcnt lgkmcnt(2)
    v_mfma_f32_32x32x16_bf16 v[32:47], v[144:147], v[68:71], v[32:47]
    s_waitcnt lgkmcnt(1)
    v_mfma_f32_32x32x16_bf16 v[32:47], v[164:167], v[72:75], v[32:47]
    s_waitcnt lgkmcnt(0)
    v_mfma_f32_32x32x16_bf16 v[32:47], v[176:179], v[76:79], v[32:47]
    ds_read_b128 v[140:143], v248 offset:128
    ds_read_b128 v[144:147], v249 offset:128
    ds_read_b128 v[164:167], v248 offset:192
    ds_read_b128 v[176:179], v249 offset:192
    s_waitcnt lgkmcnt(3)
    v_mfma_f32_32x32x16_bf16 v[32:47], v[140:143], v[80:83], v[32:47]
    s_waitcnt lgkmcnt(2)
    v_mfma_f32_32x32x16_bf16 v[32:47], v[144:147], v[84:87], v[32:47]
    s_waitcnt lgkmcnt(1)
    v_mfma_f32_32x32x16_bf16 v[32:47], v[164:167], v[88:91], v[32:47]
    s_waitcnt lgkmcnt(0)
    v_mfma_f32_32x32x16_bf16 v[32:47], v[176:179], v[92:95], v[32:47]
    ds_read_b128 v[64:67], v241 offset:0
    ds_read_b128 v[68:71], v241 offset:64
    ds_read_b128 v[72:75], v241 offset:128
    ds_read_b128 v[76:79], v241 offset:192
    ds_read_b128 v[80:83], v241 offset:4352
    ds_read_b128 v[84:87], v241 offset:4416
    ds_read_b128 v[88:91], v241 offset:4480
    ds_read_b128 v[92:95], v241 offset:4544
    ds_read_b128 v[96:99], v241 offset:8704
    ds_read_b128 v[100:103], v241 offset:8768
    ds_read_b128 v[104:107], v241 offset:8832
    ds_read_b128 v[108:111], v241 offset:8896
    v_lshrrev_b32 v252, 4, v246
    v_lshrrev_b32 v253, 1, v252
    s_lshl_b32 s61, s32, 1
    v_add_u32 v253, s61, v253
    v_and_b32 v248, 3, v246
    v_xor_b32 v253, v253, v248
    v_lshlrev_b32 v253, 4, v253
    v_and_b32 v252, 1, v252
    v_lshl_add_u32 v253, v252, 3, v253
    v_lshl_add_u32 v253, v248, 8, v253
    v_bfe_u32 v252, v246, 2, 2
    v_mul_u32_u24 v252, 1088, v252
    v_add_u32 v253, v253, v252
    v_add_u32 v253, 49152, v253
    ds_read_b64 v[228:229], v253 offset:0
    ds_read_b64 v[230:231], v253 offset:4352
    ds_read_b64 v[232:233], v253 offset:8704
    s_mov_b32 s61, 0xbfb8aa3b
    v_lshlrev_b32 v31, 16, v31
    v_mul_f32 v31, s61, v31
    v_cvt_pk_bf16_f32 v252, v31, v31
    v_and_b32 v253, 0xffff0000, v252
    v_sub_f32 v248, v31, v253
    v_cvt_pk_bf16_f32 v252, v253, v248
    v_cmp_gt_u32 vcc, 32, v246
    s_nop 1
    v_cndmask_b32 v252, 0, v252, vcc
    s_waitcnt lgkmcnt(14)
    v_mfma_f32_16x16x32_bf16 v[128:131], v[48:51], v[64:67], 0
    s_waitcnt lgkmcnt(13)
    v_mfma_f32_16x16x32_bf16 v[128:131], v[52:55], v[68:71], v[128:131]
    s_waitcnt lgkmcnt(12)
    v_mfma_f32_16x16x32_bf16 v[128:131], v[56:59], v[72:75], v[128:131]
    s_waitcnt lgkmcnt(11)
    v_mfma_f32_16x16x32_bf16 v[128:131], v[60:63], v[76:79], v[128:131]
    s_waitcnt lgkmcnt(10)
    v_mfma_f32_16x16x32_bf16 v[132:135], v[48:51], v[80:83], 0
    s_waitcnt lgkmcnt(9)
    v_mfma_f32_16x16x32_bf16 v[132:135], v[52:55], v[84:87], v[132:135]
    s_waitcnt lgkmcnt(8)
    v_mfma_f32_16x16x32_bf16 v[132:135], v[56:59], v[88:91], v[132:135]
    s_waitcnt lgkmcnt(7)
    v_mfma_f32_16x16x32_bf16 v[132:135], v[60:63], v[92:95], v[132:135]
    s_waitcnt lgkmcnt(6)
    v_mfma_f32_16x16x32_bf16 v[136:139], v[48:51], v[96:99], 0
    s_waitcnt lgkmcnt(5)
    v_mfma_f32_16x16x32_bf16 v[136:139], v[52:55], v[100:103], v[136:139]
    s_waitcnt lgkmcnt(4)
    v_mfma_f32_16x16x32_bf16 v[136:139], v[56:59], v[104:107], v[136:139]
    s_waitcnt lgkmcnt(3)
    v_mfma_f32_16x16x32_bf16 v[136:139], v[60:63], v[108:111], v[136:139]
    v_mul_f32 v32, s61, v32
    v_mul_f32 v33, s61, v33
    v_mul_f32 v34, s61, v34
    v_mul_f32 v35, s61, v35
    v_cvt_pk_bf16_f32 v16, v32, v33
    v_cvt_pk_bf16_f32 v17, v34, v35
    v_mov_b32 v18, v252
    v_mov_b32 v19, 0
    s_nop 1
    v_permlane32_swap_b32 v16, v18
    v_permlane32_swap_b32 v17, v19
    v_mul_f32 v36, s61, v36
    v_mul_f32 v37, s61, v37
    v_mul_f32 v38, s61, v38
    v_mul_f32 v39, s61, v39
    v_cvt_pk_bf16_f32 v20, v36, v37
    v_cvt_pk_bf16_f32 v21, v38, v39
    v_mov_b32 v22, v252
    v_mov_b32 v23, 0
    s_nop 1
    v_permlane32_swap_b32 v20, v22
    v_permlane32_swap_b32 v21, v23
    v_mul_f32 v40, s61, v40
    v_mul_f32 v41, s61, v41
    v_mul_f32 v42, s61, v42
    v_mul_f32 v43, s61, v43
    v_cvt_pk_bf16_f32 v24, v40, v41
    v_cvt_pk_bf16_f32 v25, v42, v43
    v_mov_b32 v26, v252
    v_mov_b32 v27, 0
    s_nop 1
    v_permlane32_swap_b32 v24, v26
    v_permlane32_swap_b32 v25, v27
K2_noX:
    s_waitcnt lgkmcnt(0)
    s_add_u32 m0, s3, 16384
    s_nop 0
    buffer_load_dwordx4 v[200:201], s[8:11], 0 idxen offen lds
    buffer_load_dwordx4 v[202:203], s[88:91], 0 idxen offen offset:1024 lds
    buffer_load_dwordx4 v[152:155], v[204:205], s[12:15], 0 idxen offen
    v_mov_b32 v28, v16
    v_mov_b32 v29, v17
    v_mov_b32 v30, v18
    v_mov_b32 v31, v19
    s_waitcnt vmcnt(6) lgkmcnt(0)
    v_cmp_gt_u32 vcc, -2, v168
    s_and_saveexec_b64 s[4:5], vcc
    s_cbranch_execz K2_bd0
    v_lshlrev_b32 v140, 16, v120
    v_lshlrev_b32 v141, 16, v112
    v_sub_f32 v140, v140, v141
    v_and_b32 v141, 0xffff0000, v120
    v_and_b32 v142, 0xffff0000, v112
    v_sub_f32 v141, v141, v142
    v_lshlrev_b32 v142, 16, v121
    v_lshlrev_b32 v143, 16, v113
    v_sub_f32 v142, v142, v143
    v_cvt_pk_bf16_f32 v164, v140, v141
    v_cvt_pk_bf16_f32 v165, v142, v142
    v_lshlrev_b32 v140, 16, v164
    v_and_b32 v141, 0xffff0000, v164
    v_and_b32 v142, 0xffff0000, v165
    v_mul_f32 v140, v140, v140
    v_mul_f32 v141, v141, v141
    v_mul_f32 v142, v142, v142
    v_cvt_pk_bf16_f32 v166, v140, v141
    v_cvt_pk_bf16_f32 v167, v142, v142
    v_lshlrev_b32 v140, 16, v166
    v_and_b32 v141, 0xffff0000, v166
    v_and_b32 v142, 0xffff0000, v167
    v_add_f32 v140, v140, v141
    v_add_f32 v140, v140, v142
    v_cvt_pk_bf16_f32 v166, v140, v140
    v_mov_b32 v140, 0x3f80
    v_lshl_or_b32 v142, v164, 16, v140
    v_alignbit_b32 v143, v165, v164, 16
    v_bfe_u32 v249, v168, 14, 3
    v_lshlrev_b32 v252, 6, v172
    v_lshl_add_u32 v252, v249, 3, v252
    v_add_u32 v252, 65536, v252
    ds_write_b64 v252, v[142:143]
    v_lshlrev_b32 v252, 4, v172
    v_add_u32 v253, 134656, v252
    ds_write_b32 v253, v166
    v_lshl_add_u32 v252, v249, 1, v252
    v_add_u32 v252, 120832, v252
    ds_write_b16 v252, v140
K2_bd0:
    s_mov_b64 exec, s[4:5]
    v_cmp_gt_u32 vcc, -2, v169
    s_and_saveexec_b64 s[4:5], vcc
    s_cbranch_execz K2_bd1
    v_lshlrev_b32 v140, 16, v122
    v_lshlrev_b32 v141, 16, v114
    v_sub_f32 v140, v140, v141
    v_and_b32 v141, 0xffff0000, v122
    v_and_b32 v142, 0xffff0000, v114
    v_sub_f32 v141, v141, v142
    v_lshlrev_b32 v142, 16, v123
    v_lshlrev_b32 v143, 16, v115
    v_sub_f32 v142, v142, v143
    v_cvt_pk_bf16_f32 v164, v140, v141
    v_cvt_pk_bf16_f32 v165, v142, v142
    v_lshlrev_b32 v140, 16, v164
    v_and_b32 v141, 0xffff0000, v164
    v_and_b32 v142, 0xffff0000, v165
    v_mul_f32 v140, v140, v140
    v_mul_f32 v141, v141, v141
    v_mul_f32 v142, v142, v142
    v_cvt_pk_bf16_f32 v166, v140, v141
    v_cvt_pk_bf16_f32 v167, v142, v142
    v_lshlrev_b32 v140, 16, v166
    v_and_b32 v141, 0xffff0000, v166
    v_and_b32 v142, 0xffff0000, v167
    v_add_f32 v140, v140, v141
    v_add_f32 v140, v140, v142
    v_cvt_pk_bf16_f32 v166, v140, v140
    v_mov_b32 v140, 0x3f80
    v_lshl_or_b32 v142, v164, 16, v140
    v_alignbit_b32 v143, v165, v164, 16
    v_bfe_u32 v249, v169, 14, 3
    v_lshlrev_b32 v252, 6, v173
    v_lshl_add_u32 v252, v249, 3, v252
    v_add_u32 v252, 65536, v252
    ds_write_b64 v252, v[142:143]
    v_lshlrev_b32 v252, 4, v173
    v_add_u32 v253, 134656, v252
    ds_write_b32 v253, v166
    v_lshl_add_u32 v252, v249, 1, v252
    v_add_u32 v252, 120832, v252
    ds_write_b16 v252, v140
K2_bd1:
    s_mov_b64 exec, s[4:5]
    v_cmp_gt_u32 vcc, -2, v170
    s_and_saveexec_b64 s[4:5], vcc
    s_cbranch_execz K2_bd2
    v_lshlrev_b32 v140, 16, v124
    v_lshlrev_b32 v141, 16, v116
    v_sub_f32 v140, v140, v141
    v_and_b32 v141, 0xffff0000, v124
    v_and_b32 v142, 0xffff0000, v116
    v_sub_f32 v141, v141, v142
    v_lshlrev_b32 v142, 16, v125
    v_lshlrev_b32 v143, 16, v117
    v_sub_f32 v142, v142, v143
    v_cvt_pk_bf16_f32 v164, v140, v141
    v_cvt_pk_bf16_f32 v165, v142, v142
    v_lshlrev_b32 v140, 16, v164
    v_and_b32 v141, 0xffff0000, v164
    v_and_b32 v142, 0xffff0000, v165
    v_mul_f32 v140, v140, v140
    v_mul_f32 v141, v141, v141
    v_mul_f32 v142, v142, v142
    v_cvt_pk_bf16_f32 v166, v140, v141
    v_cvt_pk_bf16_f32 v167, v142, v142
    v_lshlrev_b32 v140, 16, v166
    v_and_b32 v141, 0xffff0000, v166
    v_and_b32 v142, 0xffff0000, v167
    v_add_f32 v140, v140, v141
    v_add_f32 v140, v140, v142
    v_cvt_pk_bf16_f32 v166, v140, v140
    v_mov_b32 v140, 0x3f80
    v_lshl_or_b32 v142, v164, 16, v140
    v_alignbit_b32 v143, v165, v164, 16
    v_bfe_u32 v249, v170, 14, 3
    v_lshlrev_b32 v252, 6, v174
    v_lshl_add_u32 v252, v249, 3, v252
    v_add_u32 v252, 65536, v252
    ds_write_b64 v252, v[142:143]
    v_lshlrev_b32 v252, 4, v174
    v_add_u32 v253, 134656, v252
    ds_write_b32 v253, v166
    v_lshl_add_u32 v252, v249, 1, v252
    v_add_u32 v252, 120832, v252
    ds_write_b16 v252, v140
K2_bd2:
    s_mov_b64 exec, s[4:5]
    v_cmp_gt_u32 vcc, -2, v171
    s_and_saveexec_b64 s[4:5], vcc
    s_cbranch_execz K2_bd3
    v_lshlrev_b32 v140, 16, v126
    v_lshlrev_b32 v141, 16, v118
    v_sub_f32 v140, v140, v141
    v_and_b32 v141, 0xffff0000, v126
    v_and_b32 v142, 0xffff0000, v118
    v_sub_f32 v141, v141, v142
    v_lshlrev_b32 v142, 16, v127
    v_lshlrev_b32 v143, 16, v119
    v_sub_f32 v142, v142, v143
    v_cvt_pk_bf16_f32 v164, v140, v141
    v_cvt_pk_bf16_f32 v165, v142, v142
    v_lshlrev_b32 v140, 16, v164
    v_and_b32 v141, 0xffff0000, v164
    v_and_b32 v142, 0xffff0000, v165
    v_mul_f32 v140, v140, v140
    v_mul_f32 v141, v141, v141
    v_mul_f32 v142, v142, v142
    v_cvt_pk_bf16_f32 v166, v140, v141
    v_cvt_pk_bf16_f32 v167, v142, v142
    v_lshlrev_b32 v140, 16, v166
    v_and_b32 v141, 0xffff0000, v166
    v_and_b32 v142, 0xffff0000, v167
    v_add_f32 v140, v140, v141
    v_add_f32 v140, v140, v142
    v_cvt_pk_bf16_f32 v166, v140, v140
    v_mov_b32 v140, 0x3f80
    v_lshl_or_b32 v142, v164, 16, v140
    v_alignbit_b32 v143, v165, v164, 16
    v_bfe_u32 v249, v171, 14, 3
    v_lshlrev_b32 v252, 6, v175
    v_lshl_add_u32 v252, v249, 3, v252
    v_add_u32 v252, 65536, v252
    ds_write_b64 v252, v[142:143]
    v_lshlrev_b32 v252, 4, v175
    v_add_u32 v253, 134656, v252
    ds_write_b32 v253, v166
    v_lshl_add_u32 v252, v249, 1, v252
    v_add_u32 v252, 120832, v252
    ds_write_b16 v252, v140
K2_bd3:
    s_mov_b64 exec, s[4:5]
    s_add_u32 m0, s3, 32768
    s_nop 0
    buffer_load_dwordx4 v[206:207], s[8:11], 0 idxen offen lds
    buffer_load_dwordx4 v[208:209], s[88:91], 0 idxen offen offset:1024 lds
    buffer_load_dwordx4 v[156:159], v[210:211], s[12:15], 0 idxen offen
    s_cmp_eq_u32 s74, 1
    s_cbranch_scc1 K2_nodp
    s_nop 7
    v_mfma_f32_32x32x16_bf16 v[64:79], v[224:227], v[224:227], 0
    v_mfma_f32_32x32x16_bf16 v[80:95], v[224:227], v[224:227], 0
    v_mfma_f32_32x32x16_bf16 v[96:111], v[224:227], v[224:227], 0
    s_mov_b32 s74, 1
K2_nodp:
    v_mfma_f32_32x32x16_bf16 v[112:127], v[224:227], v[224:227], 0
    s_mov_b32 s45, -1
    v_add_u32 v244, 1024, v244
    v_add_u32 v245, 1024, v245
    s_waitcnt lgkmcnt(0)
    s_barrier
    s_cmp_eq_u32 s42, 0
    s_cbranch_scc1 K2_loopdone
    s_waitcnt vmcnt(6)
    ds_read_b64_tr_b16 v[140:141], v240 offset:0
    ds_read_b64_tr_b16 v[142:143], v240 offset:256
    ds_read_b64_tr_b16 v[144:145], v240 offset:1024
    ds_read_b64_tr_b16 v[146:147], v240 offset:1280
    ds_read_b128 v[164:167], v242 offset:0
    s_add_u32 m0, s3, 49152
    s_cmp_eq_u32 s92, s93
    buffer_load_dwordx4 v[234:235], s[8:11], 0 idxen offen lds
    buffer_load_dwordx4 v[236:237], s[88:91], 0 idxen offen offset:1024 lds
    buffer_load_dwordx4 v[160:163], v[238:239], s[12:15], 0 idxen offen
    ds_read_u16 v234, v244 offset:0
    ds_read_u16 v236, v244 offset:128
    ds_read_b32 v238, v245 offset:4
    s_cbranch_scc1 K2_ev4
K2_evr4:
    v_add_u32 v244, 256, v244
    v_add_u32 v245, 256, v245
    v_add_u32 v242, 512, v242
    v_mfma_f32_32x32x16_bf16 v[48:63], v[148:151], v[4:7], 0
    s_waitcnt lgkmcnt(3)
    v_mfma_f32_32x32x16_bf16 v[48:63], v[164:167], v[28:31], v[48:63]
    v_mfma_f32_32x32x16_bf16 v[48:63], v[8:11], v[140:143], v[48:63]
    v_mfma_f32_32x32x16_bf16 v[48:63], v[12:15], v[144:147], v[48:63]
    s_waitcnt lgkmcnt(0)
    s_nop 7
    s_sub_u32 s92, s92, 1
    s_cbranch_scc1 K2_ex3
K2_it0:
    s_setprio 1
    s_waitcnt vmcnt(6)
    v_mfma_f32_32x32x16_bf16 v[32:47], v[152:155], v[4:7], 0
    v_exp_f32 v184, v48
    s_cmp_eq_u32 s92, s93
    v_exp_f32 v185, v49
    s_cbranch_scc1 K2_ev0
K2_evr0:
    v_exp_f32 v186, v50
    ds_read_b64_tr_b16 v[140:141], v240 offset:16384
    v_exp_f32 v187, v51
    ds_read_b64_tr_b16 v[142:143], v240 offset:16640
    v_exp_f32 v188, v52
    ds_read_b64_tr_b16 v[144:145], v240 offset:17408
    v_exp_f32 v189, v53
    ds_read_b64_tr_b16 v[146:147], v240 offset:17664
    v_exp_f32 v190, v54
    ds_read_b128 v[164:167], v242 offset:0
    v_exp_f32 v191, v55
    ds_read_b64_tr_b16 v[168:169], v243 offset:0
    v_pk_add_f32 v[184:185], v[184:185], 1.0 op_sel_hi:[1,0]
    v_pk_add_f32 v[186:187], v[186:187], 1.0 op_sel_hi:[1,0]
    v_pk_add_f32 v[188:189], v[188:189], 1.0 op_sel_hi:[1,0]
    v_pk_add_f32 v[190:191], v[190:191], 1.0 op_sel_hi:[1,0]
    v_rcp_f32 v184, v184
    ds_read_b64_tr_b16 v[170:171], v243 offset:512
    v_rcp_f32 v185, v185
    ds_read_b64_tr_b16 v[172:173], v243 offset:1024
    v_rcp_f32 v186, v186
    ds_read_b64_tr_b16 v[174:175], v243 offset:1536
    v_rcp_f32 v187, v187
    s_add_u32 m0, s3, 0
    s_waitcnt lgkmcnt(4)
    v_mfma_f32_32x32x16_bf16 v[32:47], v[164:167], v[28:31], v[32:47]
    v_rcp_f32 v188, v188
    buffer_load_dwordx4 v[234:235], s[8:11], 0 idxen offen lds
    v_rcp_f32 v189, v189
    buffer_load_dwordx4 v[236:237], s[88:91], 0 idxen offen offset:1024 lds
    v_rcp_f32 v190, v190
    buffer_load_dwordx4 v[148:151], v[238:239], s[12:15], 0 idxen offen
    v_rcp_f32 v191, v191
    ds_read_u16 v234, v244 offset:0
    v_pk_mul_f32 v[192:193], v[48:49], v[184:185]
    v_pk_mul_f32 v[194:195], v[50:51], v[186:187]
    v_pk_mul_f32 v[196:197], v[52:53], v[188:189]
    v_pk_mul_f32 v[198:199], v[54:55], v[190:191]
    v_cvt_pk_bf16_f32 v176, v192, v193
    v_cvt_pk_bf16_f32 v177, v194, v195
    v_cvt_pk_bf16_f32 v178, v196, v197
    v_cvt_pk_bf16_f32 v179, v198, v199
    v_mfma_f32_32x32x16_bf16 v[32:47], v[8:11], v[140:143], v[32:47]
    v_exp_f32 v184, v56
    ds_read_u16 v236, v244 offset:128
    v_exp_f32 v185, v57
    ds_read_b32 v238, v245 offset:4
    v_exp_f32 v186, v58
    s_setprio 0
    v_exp_f32 v187, v59
    v_mfma_f32_32x32x16_bf16 v[32:47], v[12:15], v[144:147], v[32:47]
    v_exp_f32 v188, v60
    s_sub_u32 s92, s92, 1
    v_exp_f32 v189, v61
    v_exp_f32 v190, v62
    v_exp_f32 v191, v63
    v_pk_add_f32 v[184:185], v[184:185], 1.0 op_sel_hi:[1,0]
    v_pk_add_f32 v[186:187], v[186:187], 1.0 op_sel_hi:[1,0]
    v_pk_add_f32 v[188:189], v[188:189], 1.0 op_sel_hi:[1,0]
    v_pk_add_f32 v[190:191], v[190:191], 1.0 op_sel_hi:[1,0]
    s_waitcnt lgkmcnt(3)
    v_mfma_f32_32x32x16_bf16 v[112:127], v[176:179], v[168:171], v[112:127]
    v_rcp_f32 v184, v184
    v_rcp_f32 v185, v185
    v_rcp_f32 v186, v186
    v_rcp_f32 v187, v187
    v_rcp_f32 v188, v188
    v_rcp_f32 v189, v189
    v_rcp_f32 v190, v190
    v_rcp_f32 v191, v191
    v_pk_mul_f32 v[192:193], v[56:57], v[184:185]
    v_pk_mul_f32 v[194:195], v[58:59], v[186:187]
    v_pk_mul_f32 v[196:197], v[60:61], v[188:189]
    v_pk_mul_f32 v[198:199], v[62:63], v[190:191]
    v_cvt_pk_bf16_f32 v180, v192, v193
    v_cvt_pk_bf16_f32 v181, v194, v195
    v_cvt_pk_bf16_f32 v182, v196, v197
    v_cvt_pk_bf16_f32 v183, v198, v199
    s_nop 1
    v_mfma_f32_32x32x16_bf16 v[112:127], v[180:183], v[172:175], v[112:127]
    s_cbranch_scc1 K2_ex0
K2_it1:
    s_setprio 1
    s_waitcnt vmcnt(6)
    v_mfma_f32_32x32x16_bf16 v[48:63], v[156:159], v[4:7], 0
    v_exp_f32 v184, v32
    s_cmp_eq_u32 s92, s93
    v_exp_f32 v185, v33
    s_cbranch_scc1 K2_ev1
K2_evr1:
    v_exp_f32 v186, v34
    ds_read_b64_tr_b16 v[140:141], v240 offset:32768
    v_exp_f32 v187, v35
    ds_read_b64_tr_b16 v[142:143], v240 offset:33024
    v_exp_f32 v188, v36
    ds_read_b64_tr_b16 v[144:145], v240 offset:33792
    v_exp_f32 v189, v37
    ds_read_b64_tr_b16 v[146:147], v240 offset:34048
    v_exp_f32 v190, v38
    ds_read_b128 v[164:167], v242 offset:512
    v_exp_f32 v191, v39
    ds_read_b64_tr_b16 v[168:169], v243 offset:2048
    v_pk_add_f32 v[184:185], v[184:185], 1.0 op_sel_hi:[1,0]
    v_pk_add_f32 v[186:187], v[186:187], 1.0 op_sel_hi:[1,0]
    v_pk_add_f32 v[188:189], v[188:189], 1.0 op_sel_hi:[1,0]
    v_pk_add_f32 v[190:191], v[190:191], 1.0 op_sel_hi:[1,0]
    v_rcp_f32 v184, v184
    ds_read_b64_tr_b16 v[170:171], v243 offset:2560
    v_rcp_f32 v185, v185
    ds_read_b64_tr_b16 v[172:173], v243 offset:3072
    v_rcp_f32 v186, v186
    ds_read_b64_tr_b16 v[174:175], v243 offset:3584
    v_rcp_f32 v187, v187
    s_add_u32 m0, s3, 16384
    s_waitcnt lgkmcnt(4)
    v_mfma_f32_32x32x16_bf16 v[48:63], v[164:167], v[28:31], v[48:63]
    v_rcp_f32 v188, v188
    buffer_load_dwordx4 v[234:235], s[8:11], 0 idxen offen lds
    v_rcp_f32 v189, v189
    buffer_load_dwordx4 v[236:237], s[88:91], 0 idxen offen offset:1024 lds
    v_rcp_f32 v190, v190
    buffer_load_dwordx4 v[152:155], v[238:239], s[12:15], 0 idxen offen
    v_rcp_f32 v191, v191
    ds_read_u16 v234, v244 offset:256
    v_pk_mul_f32 v[192:193], v[32:33], v[184:185]
    v_pk_mul_f32 v[194:195], v[34:35], v[186:187]
    v_pk_mul_f32 v[196:197], v[36:37], v[188:189]
    v_pk_mul_f32 v[198:199], v[38:39], v[190:191]
    v_cvt_pk_bf16_f32 v176, v192, v193
    v_cvt_pk_bf16_f32 v177, v194, v195
    v_cvt_pk_bf16_f32 v178, v196, v197
    v_cvt_pk_bf16_f32 v179, v198, v199
    v_mfma_f32_32x32x16_bf16 v[48:63], v[8:11], v[140:143], v[48:63]
    v_exp_f32 v184, v40
    ds_read_u16 v236, v244 offset:384
    v_exp_f32 v185, v41
    ds_read_b32 v238, v245 offset:260
    v_exp_f32 v186, v42
    s_setprio 0
    v_exp_f32 v187, v43
    v_mfma_f32_32x32x16_bf16 v[48:63], v[12:15], v[144:147], v[48:63]
    v_exp_f32 v188, v44
    s_sub_u32 s92, s92, 1
    v_exp_f32 v189, v45
    v_exp_f32 v190, v46
    v_exp_f32 v191, v47
    v_pk_add_f32 v[184:185], v[184:185], 1.0 op_sel_hi:[1,0]
    v_pk_add_f32 v[186:187], v[186:187], 1.0 op_sel_hi:[1,0]
    v_pk_add_f32 v[188:189], v[188:189], 1.0 op_sel_hi:[1,0]
    v_pk_add_f32 v[190:191], v[190:191], 1.0 op_sel_hi:[1,0]
    s_waitcnt lgkmcnt(3)
    v_mfma_f32_32x32x16_bf16 v[112:127], v[176:179], v[168:171], v[112:127]
    v_rcp_f32 v184, v184
    v_rcp_f32 v185, v185
    v_rcp_f32 v186, v186
    v_rcp_f32 v187, v187
    v_rcp_f32 v188, v188
    v_rcp_f32 v189, v189
    v_rcp_f32 v190, v190
    v_rcp_f32 v191, v191
    v_pk_mul_f32 v[192:193], v[40:41], v[184:185]
    v_pk_mul_f32 v[194:195], v[42:43], v[186:187]
    v_pk_mul_f32 v[196:197], v[44:45], v[188:189]
    v_pk_mul_f32 v[198:199], v[46:47], v[190:191]
    v_cvt_pk_bf16_f32 v180, v192, v193
    v_cvt_pk_bf16_f32 v181, v194, v195
    v_cvt_pk_bf16_f32 v182, v196, v197
    v_cvt_pk_bf16_f32 v183, v198, v199
    s_nop 1
    v_mfma_f32_32x32x16_bf16 v[112:127], v[180:183], v[172:175], v[112:127]
    s_cbranch_scc1 K2_ex1
K2_it2:
    s_setprio 1
    s_waitcnt vmcnt(6)
    v_mfma_f32_32x32x16_bf16 v[32:47], v[160:163], v[4:7], 0
    v_exp_f32 v184, v48
    s_cmp_eq_u32 s92, s93
    v_exp_f32 v185, v49
    s_cbranch_scc1 K2_ev2
K2_evr2:
    v_exp_f32 v186, v50
    ds_read_b64_tr_b16 v[140:141], v240 offset:49152
    v_exp_f32 v187, v51
    ds_read_b64_tr_b16 v[142:143], v240 offset:49408
    v_exp_f32 v188, v52
    ds_read_b64_tr_b16 v[144:145], v240 offset:50176
    v_exp_f32 v189, v53
    ds_read_b64_tr_b16 v[146:147], v240 offset:50432
    v_exp_f32 v190, v54
    ds_read_b128 v[164:167], v242 offset:1024
    v_exp_f32 v191, v55
    ds_read_b64_tr_b16 v[168:169], v243 offset:4096
    v_pk_add_f32 v[184:185], v[184:185], 1.0 op_sel_hi:[1,0]
    v_pk_add_f32 v[186:187], v[186:187], 1.0 op_sel_hi:[1,0]
    v_pk_add_f32 v[188:189], v[188:189], 1.0 op_sel_hi:[1,0]
    v_pk_add_f32 v[190:191], v[190:191], 1.0 op_sel_hi:[1,0]
    v_rcp_f32 v184, v184
    ds_read_b64_tr_b16 v[170:171], v243 offset:4608
    v_rcp_f32 v185, v185
    ds_read_b64_tr_b16 v[172:173], v243 offset:5120
    v_rcp_f32 v186, v186
    ds_read_b64_tr_b16 v[174:175], v243 offset:5632
    v_rcp_f32 v187, v187
    s_add_u32 m0, s3, 32768
    s_waitcnt lgkmcnt(4)
    v_mfma_f32_32x32x16_bf16 v[32:47], v[164:167], v[28:31], v[32:47]
    v_rcp_f32 v188, v188
    buffer_load_dwordx4 v[234:235], s[8:11], 0 idxen offen lds
    v_rcp_f32 v189, v189
    buffer_load_dwordx4 v[236:237], s[88:91], 0 idxen offen offset:1024 lds
    v_rcp_f32 v190, v190
    buffer_load_dwordx4 v[156:159], v[238:239], s[12:15], 0 idxen offen
    v_rcp_f32 v191, v191
    ds_read_u16 v234, v244 offset:512
    v_pk_mul_f32 v[192:193], v[48:49], v[184:185]
    v_pk_mul_f32 v[194:195], v[50:51], v[186:187]
    v_pk_mul_f32 v[196:197], v[52:53], v[188:189]
    v_pk_mul_f32 v[198:199], v[54:55], v[190:191]
    v_cvt_pk_bf16_f32 v176, v192, v193
    v_cvt_pk_bf16_f32 v177, v194, v195
    v_cvt_pk_bf16_f32 v178, v196, v197
    v_cvt_pk_bf16_f32 v179, v198, v199
    v_mfma_f32_32x32x16_bf16 v[32:47], v[8:11], v[140:143], v[32:47]
    v_exp_f32 v184, v56
    ds_read_u16 v236, v244 offset:640
    v_exp_f32 v185, v57
    ds_read_b32 v238, v245 offset:516
    v_exp_f32 v186, v58
    s_setprio 0
    v_exp_f32 v187, v59
    v_mfma_f32_32x32x16_bf16 v[32:47], v[12:15], v[144:147], v[32:47]
    v_exp_f32 v188, v60
    s_sub_u32 s92, s92, 1
    v_exp_f32 v189, v61
    v_exp_f32 v190, v62
    v_exp_f32 v191, v63
    v_pk_add_f32 v[184:185], v[184:185], 1.0 op_sel_hi:[1,0]
    v_pk_add_f32 v[186:187], v[186:187], 1.0 op_sel_hi:[1,0]
    v_pk_add_f32 v[188:189], v[188:189], 1.0 op_sel_hi:[1,0]
    v_pk_add_f32 v[190:191], v[190:191], 1.0 op_sel_hi:[1,0]
    s_waitcnt lgkmcnt(3)
    v_mfma_f32_32x32x16_bf16 v[112:127], v[176:179], v[168:171], v[112:127]
    v_rcp_f32 v184, v184
    v_rcp_f32 v185, v185
    v_rcp_f32 v186, v186
    v_rcp_f32 v187, v187
    v_rcp_f32 v188, v188
    v_rcp_f32 v189, v189
    v_rcp_f32 v190, v190
    v_rcp_f32 v191, v191
    v_pk_mul_f32 v[192:193], v[56:57], v[184:185]
    v_pk_mul_f32 v[194:195], v[58:59], v[186:187]
    v_pk_mul_f32 v[196:197], v[60:61], v[188:189]
    v_pk_mul_f32 v[198:199], v[62:63], v[190:191]
    v_cvt_pk_bf16_f32 v180, v192, v193
    v_cvt_pk_bf16_f32 v181, v194, v195
    v_cvt_pk_bf16_f32 v182, v196, v197
    v_cvt_pk_bf16_f32 v183, v198, v199
    s_nop 1
    v_mfma_f32_32x32x16_bf16 v[112:127], v[180:183], v[172:175], v[112:127]
    s_cbranch_scc1 K2_ex2
K2_it3:
    s_setprio 1
    s_waitcnt vmcnt(6)
    v_mfma_f32_32x32x16_bf16 v[48:63], v[148:151], v[4:7], 0
    v_exp_f32 v184, v32
    s_cmp_eq_u32 s92, s93
    v_exp_f32 v185, v33
    s_cbranch_scc1 K2_ev3
K2_evr3:
    v_exp_f32 v186, v34
    ds_read_b64_tr_b16 v[140:141], v240 offset:0
    v_exp_f32 v187, v35
    ds_read_b64_tr_b16 v[142:143], v240 offset:256
    v_exp_f32 v188, v36
    ds_read_b64_tr_b16 v[144:145], v240 offset:1024
    v_exp_f32 v189, v37
    ds_read_b64_tr_b16 v[146:147], v240 offset:1280
    v_exp_f32 v190, v38
    ds_read_b128 v[164:167], v242 offset:1536
    v_exp_f32 v191, v39
    ds_read_b64_tr_b16 v[168:169], v243 offset:6144
    v_pk_add_f32 v[184:185], v[184:185], 1.0 op_sel_hi:[1,0]
    v_pk_add_f32 v[186:187], v[186:187], 1.0 op_sel_hi:[1,0]
    v_pk_add_f32 v[188:189], v[188:189], 1.0 op_sel_hi:[1,0]
    v_pk_add_f32 v[190:191], v[190:191], 1.0 op_sel_hi:[1,0]
    v_rcp_f32 v184, v184
    ds_read_b64_tr_b16 v[170:171], v243 offset:6656
    v_rcp_f32 v185, v185
    ds_read_b64_tr_b16 v[172:173], v243 offset:7168
    v_rcp_f32 v186, v186
    ds_read_b64_tr_b16 v[174:175], v243 offset:7680
    v_rcp_f32 v187, v187
    s_add_u32 m0, s3, 49152
    s_waitcnt lgkmcnt(4)
    v_mfma_f32_32x32x16_bf16 v[48:63], v[164:167], v[28:31], v[48:63]
    v_rcp_f32 v188, v188
    buffer_load_dwordx4 v[234:235], s[8:11], 0 idxen offen lds
    v_rcp_f32 v189, v189
    buffer_load_dwordx4 v[236:237], s[88:91], 0 idxen offen offset:1024 lds
    v_rcp_f32 v190, v190
    buffer_load_dwordx4 v[160:163], v[238:239], s[12:15], 0 idxen offen
    v_rcp_f32 v191, v191
    ds_read_u16 v234, v244 offset:768
    v_pk_mul_f32 v[192:193], v[32:33], v[184:185]
    v_pk_mul_f32 v[194:195], v[34:35], v[186:187]
    v_pk_mul_f32 v[196:197], v[36:37], v[188:189]
    v_pk_mul_f32 v[198:199], v[38:39], v[190:191]
    v_cvt_pk_bf16_f32 v176, v192, v193
    v_cvt_pk_bf16_f32 v177, v194, v195
    v_cvt_pk_bf16_f32 v178, v196, v197
    v_cvt_pk_bf16_f32 v179, v198, v199
    v_mfma_f32_32x32x16_bf16 v[48:63], v[8:11], v[140:143], v[48:63]
    v_exp_f32 v184, v40
    ds_read_u16 v236, v244 offset:896
    v_exp_f32 v185, v41
    ds_read_b32 v238, v245 offset:772
    v_exp_f32 v186, v42
    s_setprio 0
    v_exp_f32 v187, v43
    v_mfma_f32_32x32x16_bf16 v[48:63], v[12:15], v[144:147], v[48:63]
    v_exp_f32 v188, v44
    s_sub_u32 s92, s92, 1
    v_exp_f32 v189, v45
    v_exp_f32 v190, v46
    v_exp_f32 v191, v47
    v_pk_add_f32 v[184:185], v[184:185], 1.0 op_sel_hi:[1,0]
    v_pk_add_f32 v[186:187], v[186:187], 1.0 op_sel_hi:[1,0]
    v_pk_add_f32 v[188:189], v[188:189], 1.0 op_sel_hi:[1,0]
    v_pk_add_f32 v[190:191], v[190:191], 1.0 op_sel_hi:[1,0]
    s_waitcnt lgkmcnt(3)
    v_mfma_f32_32x32x16_bf16 v[112:127], v[176:179], v[168:171], v[112:127]
    v_rcp_f32 v184, v184
    v_rcp_f32 v185, v185
    v_rcp_f32 v186, v186
    v_rcp_f32 v187, v187
    v_rcp_f32 v188, v188
    v_rcp_f32 v189, v189
    v_rcp_f32 v190, v190
    v_rcp_f32 v191, v191
    v_add_u32 v244, 1024, v244
    v_add_u32 v245, 1024, v245
    v_add_u32 v242, 2048, v242
    v_add_u32 v243, 8192, v243
    v_pk_mul_f32 v[192:193], v[40:41], v[184:185]
    v_pk_mul_f32 v[194:195], v[42:43], v[186:187]
    v_pk_mul_f32 v[196:197], v[44:45], v[188:189]
    v_pk_mul_f32 v[198:199], v[46:47], v[190:191]
    v_cvt_pk_bf16_f32 v180, v192, v193
    v_cvt_pk_bf16_f32 v181, v194, v195
    v_cvt_pk_bf16_f32 v182, v196, v197
    v_cvt_pk_bf16_f32 v183, v198, v199
    s_nop 1
    v_mfma_f32_32x32x16_bf16 v[112:127], v[180:183], v[172:175], v[112:127]
    s_cbranch_scc1 K2_ex3
    s_branch K2_it0
K2_ex0:
    v_add_u32 v243, 2048, v243
    s_branch K2_epi0
K2_ex1:
    v_add_u32 v243, 4096, v243
    s_branch K2_epi1
K2_ex2:
    v_add_u32 v243, 6144, v243
    s_branch K2_epi0
K2_ex3:
    s_branch K2_epi1
K2_ev0:
    s_mov_b32 s69, 0
    s_branch K2_ev
K2_ev1:
    s_mov_b32 s69, 1
    s_branch K2_ev
K2_ev2:
    s_mov_b32 s69, 2
    s_branch K2_ev
K2_ev3:
    s_mov_b32 s69, 3
    s_branch K2_ev
K2_ev4:
    s_mov_b32 s69, 4
    s_branch K2_ev
K2_ev5:
    s_mov_b32 s69, 5
    s_branch K2_ev
K2_ev6:
    s_mov_b32 s69, 6
    s_branch K2_dsw
K2_ev:
    s_sub_u32 s45, s42, 2
    s_sub_u32 s45, s45, s92
K2_evx:
    s_add_u32 s4, s45, 1
    s_cmp_eq_u32 s4, s46
    s_cbranch_scc0 K2_evd
    s_add_u32 s48, s48, 1
    s_mov_b32 s46, s47
    s_mov_b32 s47, 0x7fff
    s_cmp_eq_u32 s48, 1
    s_cbranch_scc0 K2_evx2
    v_mov_b32 v28, v20
    v_mov_b32 v29, v21
    v_mov_b32 v30, v22
    v_mov_b32 v31, v23
    s_branch K2_evx
K2_evx2:
    v_mov_b32 v28, v24
    v_mov_b32 v29, v25
    v_mov_b32 v30, v26
    v_mov_b32 v31, v27
    s_branch K2_evx
K2_evd:
    s_cmp_eq_u32 s45, s49
    s_cbranch_scc0 K2_evn
K2_dsw:
    s_cmp_eq_u32 s51, 1
    s_cbranch_scc1 K2_dsw_1
    s_cmp_eq_u32 s51, 2
    s_cbranch_scc1 K2_dsw_2
    v_pk_add_f32 v[64:65], v[64:65], v[112:113]
    v_pk_add_f32 v[66:67], v[66:67], v[114:115]
    v_pk_add_f32 v[68:69], v[68:69], v[116:117]
    v_pk_add_f32 v[70:71], v[70:71], v[118:119]
    v_pk_add_f32 v[72:73], v[72:73], v[120:121]
    v_pk_add_f32 v[74:75], v[74:75], v[122:123]
    v_pk_add_f32 v[76:77], v[76:77], v[124:125]
    v_pk_add_f32 v[78:79], v[78:79], v[126:127]
    s_branch K2_dsw_c
K2_dsw_1:
    v_pk_add_f32 v[80:81], v[80:81], v[112:113]
    v_pk_add_f32 v[82:83], v[82:83], v[114:115]
    v_pk_add_f32 v[84:85], v[84:85], v[116:117]
    v_pk_add_f32 v[86:87], v[86:87], v[118:119]
    v_pk_add_f32 v[88:89], v[88:89], v[120:121]
    v_pk_add_f32 v[90:91], v[90:91], v[122:123]
    v_pk_add_f32 v[92:93], v[92:93], v[124:125]
    v_pk_add_f32 v[94:95], v[94:95], v[126:127]
    s_branch K2_dsw_c
K2_dsw_2:
    v_pk_add_f32 v[96:97], v[96:97], v[112:113]
    v_pk_add_f32 v[98:99], v[98:99], v[114:115]
    v_pk_add_f32 v[100:101], v[100:101], v[116:117]
    v_pk_add_f32 v[102:103], v[102:103], v[118:119]
    v_pk_add_f32 v[104:105], v[104:105], v[120:121]
    v_pk_add_f32 v[106:107], v[106:107], v[122:123]
    v_pk_add_f32 v[108:109], v[108:109], v[124:125]
    v_pk_add_f32 v[110:111], v[110:111], v[126:127]
K2_dsw_c:
    v_mfma_f32_32x32x16_bf16 v[112:127], v[224:227], v[224:227], 0
    s_add_u32 s51, s51, 1
    s_mov_b32 s49, s50
    s_mov_b32 s50, 0x7fff
    s_cmp_eq_u32 s69, 6
    s_cbranch_scc1 K2_evr6
    s_branch K2_evd
K2_evn:
    s_sub_u32 s4, s46, 1
    s_min_i32 s4, s4, s49
    s_sub_u32 s93, s42, 2
    s_sub_u32 s93, s93, s4
    s_cmp_eq_u32 s69, 0
    s_cbranch_scc1 K2_evr0
    s_cmp_eq_u32 s69, 1
    s_cbranch_scc1 K2_evr1
    s_cmp_eq_u32 s69, 2
    s_cbranch_scc1 K2_evr2
    s_cmp_eq_u32 s69, 3
    s_cbranch_scc1 K2_evr3
    s_cmp_eq_u32 s69, 4
    s_cbranch_scc1 K2_evr4
    s_branch K2_evr5
K2_mark:
    v_mov_b32 v248, 1
    v_mov_b32 v249, 157204
    ds_write_b32 v249, v248
    s_branch K2_rank
K2_toslow:
    s_mov_b32 s58, 1
    s_mov_b32 s59, 0
    s_waitcnt vmcnt(0)
    s_barrier
    s_branch K2_zero
K2_readdr:
    v_and_b32 v248, 31, v246
    v_lshrrev_b32 v250, 5, v246
    v_mul_u32_u24 v252, 13824, v250
    v_lshl_add_u32 v242, v248, 4, v252
    v_add_u32 v242, 120832, v242
    v_lshlrev_b32 v252, 8, v250
    v_sub_u32 v243, v240, v252
    v_subrev_u32 v243, s3, v243
    v_add_u32 v243, 65536, v243
    v_lshrrev_b32 v252, 2, v246
    v_lshlrev_b32 v252, 3, v252
    v_add_u32 v244, 148480, v252
    v_lshlrev_b32 v252, 3, v248
    v_add_u32 v245, 148480, v252
    s_branch K2_addrok
K2_epi0:
    v_mov_b32 v48, v32
    v_mov_b32 v49, v33
    v_mov_b32 v50, v34
    v_mov_b32 v51, v35
    v_mov_b32 v52, v36
    v_mov_b32 v53, v37
    v_mov_b32 v54, v38
    v_mov_b32 v55, v39
    v_mov_b32 v56, v40
    v_mov_b32 v57, v41
    v_mov_b32 v58, v42
    v_mov_b32 v59, v43
    v_mov_b32 v60, v44
    v_mov_b32 v61, v45
    v_mov_b32 v62, v46
    v_mov_b32 v63, v47
K2_epi1:
    ds_read_b64_tr_b16 v[168:169], v243 offset:0
    ds_read_b64_tr_b16 v[170:171], v243 offset:512
    ds_read_b64_tr_b16 v[172:173], v243 offset:1024
    ds_read_b64_tr_b16 v[174:175], v243 offset:1536
    s_cmp_eq_u32 s58, 0
    s_cbranch_scc0 K2_epib
    s_mov_b32 s70, 1
    v_lshlrev_b32 v248, 4, v246
    s_lshl_b32 s62, s32, 13
    s_add_u32 s62, s62, s68
    s_add_u32 s62, s62, 73728
    s_mov_b32 s84, s72
    s_mov_b32 s85, s73
    s_mov_b32 s86, 256
    s_mov_b32 s87, 0x00020000
    v_lshrrev_b32 v249, 5, v246
    v_lshlrev_b32 v249, 3, v249
    s_lshl_b32 s63, s34, 6
    buffer_load_dwordx2 v[216:217], v249, s[84:87], s63 offen offset:0
    buffer_load_dwordx2 v[218:219], v249, s[84:87], s63 offen offset:16
    buffer_load_dwordx2 v[220:221], v249, s[84:87], s63 offen offset:32
    buffer_load_dwordx2 v[222:223], v249, s[84:87], s63 offen offset:48
    buffer_load_dwordx4 v[200:203], v248, s[20:23], s62 offen offset:0
    buffer_load_dwordx4 v[204:207], v248, s[20:23], s62 offen offset:1024
    buffer_load_dwordx4 v[208:211], v248, s[20:23], s62 offen offset:2048
    buffer_load_dwordx4 v[212:215], v248, s[20:23], s62 offen offset:3072
K2_epib:
    s_cmp_eq_u32 s92, s93
    s_cbranch_scc1 K2_ev5
K2_evr5:
    v_exp_f32 v184, v48
    v_exp_f32 v185, v49
    v_exp_f32 v186, v50
    v_exp_f32 v187, v51
    v_exp_f32 v188, v52
    v_exp_f32 v189, v53
    v_exp_f32 v190, v54
    v_exp_f32 v191, v55
    v_pk_add_f32 v[184:185], v[184:185], 1.0 op_sel_hi:[1,0]
    v_pk_add_f32 v[186:187], v[186:187], 1.0 op_sel_hi:[1,0]
    v_pk_add_f32 v[188:189], v[188:189], 1.0 op_sel_hi:[1,0]
    v_pk_add_f32 v[190:191], v[190:191], 1.0 op_sel_hi:[1,0]
    v_rcp_f32 v184, v184
    v_rcp_f32 v185, v185
    v_rcp_f32 v186, v186
    v_rcp_f32 v187, v187
    v_rcp_f32 v188, v188
    v_rcp_f32 v189, v189
    v_rcp_f32 v190, v190
    v_rcp_f32 v191, v191
    v_pk_mul_f32 v[192:193], v[48:49], v[184:185]
    v_pk_mul_f32 v[194:195], v[50:51], v[186:187]
    v_pk_mul_f32 v[196:197], v[52:53], v[188:189]
    v_pk_mul_f32 v[198:199], v[54:55], v[190:191]
    v_cvt_pk_bf16_f32 v176, v192, v193
    v_cvt_pk_bf16_f32 v177, v194, v195
    v_cvt_pk_bf16_f32 v178, v196, v197
    v_cvt_pk_bf16_f32 v179, v198, v199
    v_exp_f32 v184, v56
    v_exp_f32 v185, v57
    v_exp_f32 v186, v58
    v_exp_f32 v187, v59
    v_exp_f32 v188, v60
    v_exp_f32 v189, v61
    v_exp_f32 v190, v62
    v_exp_f32 v191, v63
    v_pk_add_f32 v[184:185], v[184:185], 1.0 op_sel_hi:[1,0]
    v_pk_add_f32 v[186:187], v[186:187], 1.0 op_sel_hi:[1,0]
    v_pk_add_f32 v[188:189], v[188:189], 1.0 op_sel_hi:[1,0]
    v_pk_add_f32 v[190:191], v[190:191], 1.0 op_sel_hi:[1,0]
    v_rcp_f32 v184, v184
    v_rcp_f32 v185, v185
    v_rcp_f32 v186, v186
    v_rcp_f32 v187, v187
    v_rcp_f32 v188, v188
    v_rcp_f32 v189, v189
    v_rcp_f32 v190, v190
    v_rcp_f32 v191, v191
    v_pk_mul_f32 v[192:193], v[56:57], v[184:185]
    v_pk_mul_f32 v[194:195], v[58:59], v[186:187]
    v_pk_mul_f32 v[196:197], v[60:61], v[188:189]
    v_pk_mul_f32 v[198:199], v[62:63], v[190:191]
    v_cvt_pk_bf16_f32 v180, v192, v193
    v_cvt_pk_bf16_f32 v181, v194, v195
    v_cvt_pk_bf16_f32 v182, v196, v197
    v_cvt_pk_bf16_f32 v183, v198, v199
    s_waitcnt lgkmcnt(0)
    v_mfma_f32_32x32x16_bf16 v[112:127], v[176:179], v[168:171], v[112:127]
    v_mfma_f32_32x32x16_bf16 v[112:127], v[180:183], v[172:175], v[112:127]
    s_nop 7
    s_nop 2
    s_branch K2_ev6
K2_evr6:
K2_loopdone:
    s_cmp_eq_u32 s58, 0
    s_cbranch_scc1 K2_tail
    s_waitcnt vmcnt(0)
    s_barrier
    s_mul_i32 s61, s59, 192
    s_cmp_ge_u32 s61, 160000
    s_cbranch_scc0 K2_zero
K2_tail:
    s_cmp_eq_u32 s70, 1
    s_cbranch_scc1 K2_tail2
    v_lshlrev_b32 v248, 4, v246
    s_lshl_b32 s62, s32, 13
    s_add_u32 s62, s62, s68
    s_add_u32 s62, s62, 73728
    s_mov_b32 s84, s72
    s_mov_b32 s85, s73
    s_mov_b32 s86, 256
    s_mov_b32 s87, 0x00020000
    v_lshrrev_b32 v249, 5, v246
    v_lshlrev_b32 v249, 3, v249
    s_lshl_b32 s63, s34, 6
    buffer_load_dwordx2 v[216:217], v249, s[84:87], s63 offen offset:0
    buffer_load_dwordx2 v[218:219], v249, s[84:87], s63 offen offset:16
    buffer_load_dwordx2 v[220:221], v249, s[84:87], s63 offen offset:32
    buffer_load_dwordx2 v[222:223], v249, s[84:87], s63 offen offset:48
    buffer_load_dwordx4 v[200:203], v248, s[20:23], s62 offen offset:0
    buffer_load_dwordx4 v[204:207], v248, s[20:23], s62 offen offset:1024
    buffer_load_dwordx4 v[208:211], v248, s[20:23], s62 offen offset:2048
    buffer_load_dwordx4 v[212:215], v248, s[20:23], s62 offen offset:3072
K2_tail2:
    v_bfe_u32 v248, v246, 2, 3
    v_lshrrev_b32 v251, 5, v246
    v_lshlrev_b32 v249, 6, v248
    v_lshl_add_u32 v249, v251, 3, v249
    v_add_u32 v249, s3, v249
    v_lshrrev_b32 v248, 2, v248
    v_lshlrev_b32 v248, 5, v248
    v_sub_u32 v250, v249, v248
    v_add_u32 v249, v249, v248
    v_and_b32 v252, 31, v246
    s_mul_i32 s63, s33, 1536
    s_lshl_b32 s62, s34, 7
    s_add_u32 s63, s63, s62
    s_add_u32 s63, s63, 157248
    v_lshl_add_u32 v253, v252, 2, s63
    s_mov_b32 s84, 0x11111111
    s_mov_b32 s85, 0x11111111
    v_cvt_pk_bf16_f32 v184, v64, v65
    v_cvt_pk_bf16_f32 v185, v66, v67
    v_cvt_pk_bf16_f32 v186, v68, v69
    v_cvt_pk_bf16_f32 v187, v70, v71
    v_cvt_pk_bf16_f32 v188, v72, v73
    v_cvt_pk_bf16_f32 v189, v74, v75
    v_cvt_pk_bf16_f32 v190, v76, v77
    v_cvt_pk_bf16_f32 v191, v78, v79
    v_cvt_pk_bf16_f32 v192, v80, v81
    v_cvt_pk_bf16_f32 v193, v82, v83
    v_cvt_pk_bf16_f32 v194, v84, v85
    v_cvt_pk_bf16_f32 v195, v86, v87
    v_cvt_pk_bf16_f32 v196, v88, v89
    v_cvt_pk_bf16_f32 v197, v90, v91
    v_cvt_pk_bf16_f32 v198, v92, v93
    v_cvt_pk_bf16_f32 v199, v94, v95
    v_cvt_pk_bf16_f32 v140, v96, v97
    v_cvt_pk_bf16_f32 v141, v98, v99
    v_cvt_pk_bf16_f32 v142, v100, v101
    v_cvt_pk_bf16_f32 v143, v102, v103
    v_cvt_pk_bf16_f32 v144, v104, v105
    v_cvt_pk_bf16_f32 v145, v106, v107
    v_cvt_pk_bf16_f32 v146, v108, v109
    v_cvt_pk_bf16_f32 v147, v110, v111
    s_waitcnt vmcnt(4)
    v_mfma_f32_32x32x16_bf16 v[32:47], v[216:219], v[184:187], 0
    v_mfma_f32_32x32x16_bf16 v[32:47], v[220:223], v[188:191], v[32:47]
    v_mfma_f32_32x32x16_bf16 v[48:63], v[216:219], v[192:195], 0
    v_mfma_f32_32x32x16_bf16 v[48:63], v[220:223], v[196:199], v[48:63]
    v_mfma_f32_32x32x16_bf16 v[112:127], v[216:219], v[140:143], 0
    v_mfma_f32_32x32x16_bf16 v[112:127], v[220:223], v[144:147], v[112:127]
    s_mov_b64 exec, s[84:85]
    ds_write_b64 v249, v[184:185] offset:0
    ds_write_b64 v249, v[186:187] offset:16
    ds_write_b64 v250, v[188:189] offset:32
    ds_write_b64 v250, v[190:191] offset:48
    ds_write_b64 v249, v[192:193] offset:512
    ds_write_b64 v249, v[194:195] offset:528
    ds_write_b64 v250, v[196:197] offset:544
    ds_write_b64 v250, v[198:199] offset:560
    ds_write_b64 v249, v[140:141] offset:1024
    ds_write_b64 v249, v[142:143] offset:1040
    ds_write_b64 v250, v[144:145] offset:1056
    ds_write_b64 v250, v[146:147] offset:1072
    s_mov_b64 exec, 0xffffffff
    ds_write_b32 v253, v32 offset:0
    ds_write_b32 v253, v48 offset:512
    ds_write_b32 v253, v112 offset:1024
    s_mov_b64 exec, -1
    s_waitcnt lgkmcnt(0)
    s_barrier
    v_mfma_f32_32x32x16_bf16 v[184:199], v[224:227], v[224:227], 0
    v_and_b32 v248, 7, v246
    v_lshrrev_b32 v249, 4, v246
    v_bfe_u32 v252, v246, 2, 1
    v_lshlrev_b32 v252, 1, v252
    v_xor_b32 v249, v249, v252
    v_lshlrev_b32 v249, 4, v249
    v_lshl_add_u32 v248, v248, 6, v249
    v_bfe_u32 v249, v246, 3, 1
    v_lshl_add_u32 v252, v249, 9, v248
    v_mul_u32_u24 v249, 7680, v249
    v_add_u32 v253, v249, v248
    ds_read_b128 v[64:67], v252 offset:0
    ds_read_b128 v[68:71], v252 offset:2048
    ds_read_b128 v[72:75], v252 offset:4096
    ds_read_b128 v[76:79], v252 offset:6144
    ds_read_b128 v[80:83], v253 offset:1024
    ds_read_b128 v[84:87], v253 offset:3072
    ds_read_b128 v[88:91], v253 offset:5120
    ds_read_b128 v[92:95], v253 offset:7168
    ds_read_b128 v[96:99], v248 offset:9216
    ds_read_b128 v[100:103], v248 offset:11264
    ds_read_b128 v[104:107], v248 offset:13312
    ds_read_b128 v[108:111], v248 offset:15360
    s_mov_b32 s4, 0x00ff00ff
    s_mov_b32 s5, 0x00ff00ff
    s_mov_b64 exec, s[4:5]
    s_waitcnt lgkmcnt(8)
    ds_read_b128 v[184:187], v248 offset:8192
    ds_read_b128 v[188:191], v248 offset:10240
    ds_read_b128 v[192:195], v248 offset:12288
    ds_read_b128 v[196:199], v248 offset:14336
    s_mov_b64 exec, -1
    v_and_b32 v250, 15, v246
    v_add_u32 v250, s35, v250
    v_lshlrev_b32 v250, 8, v250
    v_lshrrev_b32 v251, 4, v246
    v_lshl_add_u32 v250, v251, 3, v250
    s_lshl_b32 s63, s32, 5
    v_add_u32 v242, s63, v250
    s_waitcnt lgkmcnt(15) vmcnt(0)
    v_mfma_f32_16x16x32_bf16 v[32:35], v[200:203], v[64:67], 0
    s_waitcnt lgkmcnt(15)
    v_mfma_f32_16x16x32_bf16 v[32:35], v[204:207], v[68:71], v[32:35]
    s_waitcnt lgkmcnt(15)
    v_mfma_f32_16x16x32_bf16 v[32:35], v[208:211], v[72:75], v[32:35]
    s_waitcnt lgkmcnt(15)
    v_mfma_f32_16x16x32_bf16 v[32:35], v[212:215], v[76:79], v[32:35]
    s_waitcnt lgkmcnt(11)
    v_mfma_f32_16x16x32_bf16 v[36:39], v[200:203], v[80:83], 0
    s_waitcnt lgkmcnt(10)
    v_mfma_f32_16x16x32_bf16 v[36:39], v[204:207], v[84:87], v[36:39]
    s_waitcnt lgkmcnt(9)
    v_mfma_f32_16x16x32_bf16 v[36:39], v[208:211], v[88:91], v[36:39]
    s_waitcnt lgkmcnt(8)
    v_mfma_f32_16x16x32_bf16 v[36:39], v[212:215], v[92:95], v[36:39]
    s_waitcnt lgkmcnt(7)
    v_mfma_f32_16x16x32_bf16 v[40:43], v[200:203], v[96:99], 0
    s_waitcnt lgkmcnt(6)
    v_mfma_f32_16x16x32_bf16 v[40:43], v[204:207], v[100:103], v[40:43]
    s_waitcnt lgkmcnt(5)
    v_mfma_f32_16x16x32_bf16 v[40:43], v[208:211], v[104:107], v[40:43]
    s_waitcnt lgkmcnt(4)
    v_mfma_f32_16x16x32_bf16 v[40:43], v[212:215], v[108:111], v[40:43]
    s_waitcnt lgkmcnt(3)
    v_mfma_f32_16x16x32_bf16 v[36:39], v[200:203], v[184:187], v[36:39]
    s_waitcnt lgkmcnt(2)
    v_mfma_f32_16x16x32_bf16 v[36:39], v[204:207], v[188:191], v[36:39]
    s_waitcnt lgkmcnt(1)
    v_mfma_f32_16x16x32_bf16 v[36:39], v[208:211], v[192:195], v[36:39]
    s_waitcnt lgkmcnt(0)
    v_mfma_f32_16x16x32_bf16 v[36:39], v[212:215], v[196:199], v[36:39]
    s_mov_b32 s6, 0xbf317218
    s_mov_b32 s4, 0xbfb8aa3b
    s_movk_i32 s63, 0x1000
    s_movk_i32 s64, 0x2000
    v_lshlrev_b32 v64, 16, v228
    v_and_b32 v65, 0xffff0000, v228
    v_lshlrev_b32 v66, 16, v229
    v_and_b32 v67, 0xffff0000, v229
    v_lshlrev_b32 v68, 16, v230
    v_and_b32 v69, 0xffff0000, v230
    v_lshlrev_b32 v70, 16, v231
    v_and_b32 v71, 0xffff0000, v231
    v_lshlrev_b32 v72, 16, v232
    v_and_b32 v73, 0xffff0000, v232
    v_lshlrev_b32 v74, 16, v233
    v_and_b32 v75, 0xffff0000, v233
    v_pk_fma_f32 v[32:33], v[32:33], s[6:7], v[128:129] op_sel_hi:[1,0,1]
    v_pk_fma_f32 v[34:35], v[34:35], s[6:7], v[130:131] op_sel_hi:[1,0,1]
    v_pk_fma_f32 v[40:41], v[40:41], s[6:7], v[136:137] op_sel_hi:[1,0,1]
    v_pk_fma_f32 v[42:43], v[42:43], s[6:7], v[138:139] op_sel_hi:[1,0,1]
    v_pk_fma_f32 v[36:37], v[36:37], s[6:7], v[132:133] op_sel_hi:[1,0,1]
    v_pk_fma_f32 v[38:39], v[38:39], s[6:7], v[134:135] op_sel_hi:[1,0,1]
    v_pk_mul_f32 v[80:81], v[32:33], s[4:5] op_sel_hi:[1,0]
    v_pk_mul_f32 v[82:83], v[34:35], s[4:5] op_sel_hi:[1,0]
    v_pk_mul_f32 v[88:89], v[40:41], s[4:5] op_sel_hi:[1,0]
    v_pk_mul_f32 v[90:91], v[42:43], s[4:5] op_sel_hi:[1,0]
    v_pk_mul_f32 v[84:85], v[36:37], s[4:5] op_sel_hi:[1,0]
    v_pk_mul_f32 v[86:87], v[38:39], s[4:5] op_sel_hi:[1,0]
    v_exp_f32 v80, v80
    v_exp_f32 v81, v81
    v_exp_f32 v82, v82
    v_exp_f32 v83, v83
    v_exp_f32 v88, v88
    v_exp_f32 v89, v89
    v_exp_f32 v90, v90
    v_exp_f32 v91, v91
    v_exp_f32 v84, v84
    v_exp_f32 v85, v85
    v_exp_f32 v86, v86
    v_exp_f32 v87, v87
    v_pk_add_f32 v[80:81], v[80:81], 1.0 op_sel_hi:[1,0]
    v_pk_add_f32 v[82:83], v[82:83], 1.0 op_sel_hi:[1,0]
    v_pk_add_f32 v[88:89], v[88:89], 1.0 op_sel_hi:[1,0]
    v_pk_add_f32 v[90:91], v[90:91], 1.0 op_sel_hi:[1,0]
    v_pk_add_f32 v[84:85], v[84:85], 1.0 op_sel_hi:[1,0]
    v_pk_add_f32 v[86:87], v[86:87], 1.0 op_sel_hi:[1,0]
    v_rcp_f32 v80, v80
    v_rcp_f32 v81, v81
    v_rcp_f32 v82, v82
    v_rcp_f32 v83, v83
    v_rcp_f32 v88, v88
    v_rcp_f32 v89, v89
    v_rcp_f32 v90, v90
    v_rcp_f32 v91, v91
    v_rcp_f32 v84, v84
    v_rcp_f32 v85, v85
    v_rcp_f32 v86, v86
    v_rcp_f32 v87, v87
    v_pk_fma_f32 v[32:33], v[32:33], v[80:81], v[64:65]
    v_pk_fma_f32 v[34:35], v[34:35], v[82:83], v[66:67]
    v_cvt_pk_bf16_f32 v168, v32, v33
    v_cvt_pk_bf16_f32 v169, v34, v35
    buffer_store_dwordx2 v[168:169], v242, s[24:27], 0 offen
    v_pk_fma_f32 v[40:41], v[40:41], v[88:89], v[72:73]
    v_pk_fma_f32 v[42:43], v[42:43], v[90:91], v[74:75]
    v_cvt_pk_bf16_f32 v172, v40, v41
    v_cvt_pk_bf16_f32 v173, v42, v43
    s_mov_b32 s84, 0x00ff00ff
    s_mov_b32 s85, 0x00ff00ff
    s_mov_b64 exec, s[84:85]
    buffer_store_dwordx2 v[172:173], v242, s[24:27], s64 offen
    s_mov_b64 exec, -1
    v_pk_fma_f32 v[36:37], v[36:37], v[84:85], v[68:69]
    v_pk_fma_f32 v[38:39], v[38:39], v[86:87], v[70:71]
    v_cvt_pk_bf16_f32 v170, v36, v37
    v_cvt_pk_bf16_f32 v171, v38, v39
    buffer_store_dwordx2 v[170:171], v242, s[24:27], s63 offen
    s_cmp_ge_u32 s32, 2
    s_cbranch_scc1 K2_nopos
    v_mul_u32_u24 v248, 171, v0
    v_lshrrev_b32 v248, 9, v248
    v_min_u32 v248, 39, v248
    v_mul_u32_u24 v249, 3, v248
    v_sub_u32 v249, v0, v249
    v_and_b32 v249, 3, v249
    v_lshlrev_b32 v250, 3, v248
    v_lshl_add_u32 v250, v249, 1, v250
    v_add_u32 v250, 163328, v250
    v_and_b32 v252, 7, v248
    v_lshlrev_b32 v252, 4, v252
    v_lshl_add_u32 v252, v249, 2, v252
    v_lshrrev_b32 v248, 3, v248
    v_cmp_lt_u32 vcc, 2, v248
    ds_read_u16 v244, v250
    s_nop 0
    v_addc_co_u32 v249, vcc, 0, v248, vcc
    v_lshl_add_u32 v252, v249, 9, v252
    v_add_u32 v252, 157252, v252
    ds_read_b32 v176, v252 offset:0
    ds_read_b32 v177, v252 offset:128
    ds_read_b32 v178, v252 offset:256
    ds_read_b32 v179, v252 offset:384
    v_cmp_eq_u32 vcc, 2, v248
    ds_read_b32 v180, v252 offset:512
    ds_read_b32 v181, v252 offset:640
    ds_read_b32 v182, v252 offset:768
    ds_read_b32 v183, v252 offset:896
    s_mul_i32 s63, s2, 240
    s_add_u32 s63, s63, 2560000
    v_lshlrev_b32 v248, 1, v0
    s_waitcnt lgkmcnt(0)
    v_add_f32 v176, v176, v177
    v_add_f32 v178, v178, v179
    v_add_f32 v176, v176, v178
    v_add_f32 v180, v180, v181
    v_add_f32 v182, v182, v183
    v_add_f32 v180, v180, v182
    v_cndmask_b32 v180, 0, v180, vcc
    v_add_f32 v249, v176, v180
    v_lshlrev_b32 v244, 16, v244
    v_fma_f32 v249, v249, s6, v244
    v_cvt_pk_bf16_f32 v249, v249, v249
    v_cmp_gt_u32 vcc, 120, v0
    s_and_saveexec_b64 s[84:85], vcc
    s_cbranch_execz K2_nopos
    buffer_store_short v249, v248, s[24:27], s63 offen
K2_nopos:
    s_mov_b64 exec, -1
K2_done:
    s_endpgm
K2_end:
.section .rodata,"a"
.p2align 6
.amdhsa_kernel k1_kernel
  .amdhsa_next_free_vgpr 128
  .amdhsa_next_free_sgpr 72
  .amdhsa_accum_offset 128
  .amdhsa_group_segment_fixed_size 0
  .amdhsa_kernarg_size 88
  .amdhsa_user_sgpr_count 2
  .amdhsa_user_sgpr_kernarg_segment_ptr 1
  .amdhsa_system_sgpr_workgroup_id_x 1
  .amdhsa_float_denorm_mode_32 3
.end_amdhsa_kernel

.p2align 6
.amdhsa_kernel k2_kernel
  .amdhsa_next_free_vgpr 254
  .amdhsa_next_free_sgpr 102
  .amdhsa_accum_offset 256
  .amdhsa_group_segment_fixed_size 0
  .amdhsa_kernarg_size 88
  .amdhsa_user_sgpr_count 2
  .amdhsa_user_sgpr_kernarg_segment_ptr 1
  .amdhsa_system_sgpr_workgroup_id_x 1
  .amdhsa_float_denorm_mode_32 3
.end_amdhsa_kernel
```
